```python
import torch

def _softmax(x, axis=-1):
    return torch.softmax(x, dim=axis)
def _gelu(x):
    return torch.nn.functional.gelu(x, approximate="tanh")
def _silu(x):
    return torch.nn.functional.silu(x)
def _sigmoid(x):
    return torch.sigmoid(x)
def _layernorm(x, axis=-1, eps=1e-5):
    m = x.mean(dim=axis, keepdim=True)
    v = x.var(dim=axis, keepdim=True, unbiased=False)
    return (x - m) / torch.sqrt(v + eps)
def _scatter_add(tgt, idx, src, axis=0):
    return tgt.clone().index_add_(axis, idx, src)
def _segment_sum(src, seg, n):
    out = torch.zeros((n,) + src.shape[1:], dtype=src.dtype)
    return out.index_add_(0, seg, src)
def _pad(x, pw):
    flat = tuple(v for pair in reversed(pw) for v in pair)
    return torch.nn.functional.pad(x, flat)

kernel_name = 'sequential_preLN__ssm_conv_h3__moe_arch_mod__prompt'

def setup_inputs():

    _w = (lambda a: (lambda t: t.to(torch.bfloat16) if t.is_floating_point() else t)(torch.as_tensor(a)))
    def _A_setup():
        B, S, D = 1, 2048, 1024
        ks = 4
        return {
            "q": _w((lambda *s: torch.randn(*s, dtype=torch.bfloat16) * 0.05)(B, S, D)),
            "k": _w((lambda *s: torch.randn(*s, dtype=torch.bfloat16) * 0.4)(B, S, D)),
            "v": _w((lambda *s: torch.randn(*s, dtype=torch.bfloat16) * 0.4)(B, S, D)),
            "shift_k": _w((lambda *s: torch.randn(*s, dtype=torch.bfloat16) * 0.4)(D, ks) * 0.5),
            "ssm_k": _w((lambda *s: torch.randn(*s, dtype=torch.bfloat16) * 0.4)(D, S) * (1.0 / S ** 0.5)),
            "ssm_D": _w((lambda *s: torch.randn(*s, dtype=torch.bfloat16) * 0.4)(D)),
        }
    _A_in = _A_setup()

    def _B_setup():
        B, S, D, F, C = 1, 2048, 1024, 3584, 1
        return {
            "x": _w((lambda *s: torch.randn(*s, dtype=torch.bfloat16) * 0.05)(B, S, D)),
            "w_r": _w((lambda *s: torch.randn(*s, dtype=torch.bfloat16) * 0.05)(D)),
            "w_gate": _w((lambda *s: torch.randn(*s, dtype=torch.bfloat16) * 0.05)(D, F)),
            "w_up": _w((lambda *s: torch.randn(*s, dtype=torch.bfloat16) * 0.05)(D, F)),
            "w_down": _w((lambda *s: torch.randn(*s, dtype=torch.bfloat16) * 0.05)(F, D)),
        }
    _B_in = _B_setup()

    return {
        "A_q": _A_in["q"],
        "A_k": _A_in["k"],
        "A_v": _A_in["v"],
        "A_shift_k": _A_in["shift_k"],
        "A_ssm_k": _A_in["ssm_k"],
        "A_ssm_D": _A_in["ssm_D"],
        "B_x": _B_in["x"],
        "B_w_r": _B_in["w_r"],
        "B_w_gate": _B_in["w_gate"],
        "B_w_up": _B_in["w_up"],
        "B_w_down": _B_in["w_down"],
    }

def reference(A_q, A_k, A_v, A_shift_k, A_ssm_k, A_ssm_D, B_x, B_w_r, B_w_gate, B_w_up, B_w_down):
    def _A_ref(q, k, v, shift_k, ssm_k, ssm_D):
        B, S, D = q.shape
        ks = shift_k.shape[-1]
        k_pad = _pad(k, ((0, 0), (ks - 1, 0), (0, 0)))
        k_shift = torch.zeros_like(k)
        for t in range(ks):
            k_shift = k_shift + k_pad[:, t:t + S, :] * shift_k[:, ks - 1 - t][None, None, :]
        kv = k_shift * v
        L = 2 * S
        kv_pad = _pad(kv, ((0, 0), (0, S), (0, 0)))
        kf_pad = _pad(ssm_k, ((0, 0), (0, S)))
        kv_f = (lambda x, axes=(-2,-1): torch.fft.rfft2(x.float(), dim=axes))(kv_pad[:, None, :, :], axes=(1, 2))
        kf_f = (lambda x, axes=(-2,-1): torch.fft.rfft2(x.float(), dim=axes))(kf_pad[:, None, :], axes=(1, 2))
        kf_f = (lambda x, *d: x.permute(*d))(kf_f, 1, 2, 0)
        y_f = kv_f * kf_f[None, :, :, :]
        y = (lambda x, s, axes=(-2,-1): torch.fft.irfft2(x, s=s, dim=axes).to(torch.bfloat16))(y_f, (1, L), axes=(1, 2))[:, 0, :S, :]
        y = y + kv * ssm_D[None, None, :]
        return q * y

    def _B_ref(x, w_r, w_gate, w_up, w_down):
        B, S, D = x.shape
        C = 1
        r = x @ w_r
        idx = torch.argsort(-r, axis=-1)[:, :C]
        idx_e = (lambda x, n, axis: torch.repeat_interleave(x, n, dim=axis))(idx.reshape(B, C, 1), D, axis=2)
        x_sel = (lambda x, i, axis: torch.take_along_dim(x, i, dim=axis))(x, idx_e, axis=1)
        g = _silu(x_sel @ w_gate)
        u = x_sel @ w_up
        y = (g * u) @ w_down
        r_sel = _sigmoid((lambda x, i, axis: torch.take_along_dim(x, i, dim=axis))(r, idx, axis=1))
        y = y * r_sel.reshape(B, C, 1)
        b_off = (torch.arange(B) * S).reshape(B, 1)
        flat_idx = (idx + b_off).reshape(B * C)
        zero = (x * 0.0).reshape(B * S, D)
        upd = _scatter_add(zero, flat_idx, y.reshape(B * C, D), axis=0)
        return x + upd.reshape(B, S, D)

    x = A_q
    h = x + _A_ref(_layernorm(x, axis=-1), A_k, A_v, A_shift_k, A_ssm_k, A_ssm_D)
    h2 = h + _B_ref(_layernorm(h, axis=-1), B_w_r, B_w_gate, B_w_up, B_w_down)
    return h2
```

```asm
; @launch grid=(256,1,1) block=(512,1,1) lds=161408
.amdgcn_target "amdgcn-amd-amdhsa--gfx950"
.text
.p2align 8
.globl sequential_preLN__ssm_conv_h3__moe_arch_mod__prompt_kernel
.type sequential_preLN__ssm_conv_h3__moe_arch_mod__prompt_kernel,@function
sequential_preLN__ssm_conv_h3__moe_arch_mod__prompt_kernel:
    s_cmp_ge_u32 s2, 256
    s_cbranch_scc1 B_end
    s_load_dwordx8 s[4:11], s[0:1], 0
    s_load_dwordx4 s[28:31], s[0:1], 96
    s_load_dwordx8 s[12:19], s[0:1], 32
    s_load_dwordx8 s[20:27], s[0:1], 64
    s_getpc_b64 s[36:37]
    v_lshlrev_b32 v2, 6, v0
    v_min_u32 v2, 18308, v2
    global_load_dword v255, v2, s[36:37]
B_ncp:
    v_lshrrev_b32 v2, 6, v0
    v_and_b32 v1, 63, v0
    v_readfirstlane_b32 s32, v2
    s_mov_b32 s34, 0xffff0000
    s_and_b32 s33, s2, 7
    s_lshr_b32 s35, s2, 3
    s_lshl_b32 s37, s33, 5
    s_add_u32 s37, s37, s35
    s_and_b32 s36, s32, 3
    v_mov_b32 v14, 161280
    v_mov_b32 v15, 1
    v_mov_b32 v2, 0
    v_and_b32 v13, 31, v1
    v_lshl_add_u32 v13, v13, 2, v14
    ds_write_b32 v13, v2
    s_barrier
    s_cmp_ge_u32 s32, 4
    s_cbranch_scc1 B_M
    s_lshl_b32 s48, s35, 17
    s_lshl_b32 s49, s33, 8
    v_and_b32 v3, 31, v0
    v_lshrrev_b32 v4, 5, v0
    s_add_u32 s48, s48, s49
    v_lshlrev_b32 v5, 3, v3
    v_lshl_add_u32 v5, v4, 14, v5
    v_add_u32 v5, s48, v5
    v_subrev_u32 v6, 6144, v5
    v_lshlrev_b32 v7, 5, v3
    s_lshl_b32 s49, s33, 10
    v_add_u32 v7, s49, v7
    s_movk_i32 s60, 4096
    s_movk_i32 s61, 8192
    s_movk_i32 s62, 12288
    s_mov_b32 s54, 0x400000
    s_mov_b32 s55, 0x20000
    s_mov_b32 s58, 0x400000
    s_mov_b32 s59, 0x20000
    s_waitcnt lgkmcnt(0)
    s_mov_b64 s[52:53], s[6:7]
    s_mov_b64 s[56:57], s[8:9]
    s_add_u32 s48, s30, 17760256
    s_addc_u32 s49, s31, 0
    s_load_dword s38, s[48:49], 0
    s_setprio 3
    global_load_dwordx4 v[54:57], v7, s[10:11]
    global_load_dwordx4 v[58:61], v7, s[10:11] offset:16
    buffer_load_dwordx2 v[16:17], v6, s[52:55], 0 offen nt
    buffer_load_dwordx2 v[18:19], v6, s[52:55], 0 offen offset:2048 nt
    buffer_load_dwordx2 v[20:21], v6, s[52:55], s60 offen nt
    buffer_load_dwordx2 v[22:23], v5, s[52:55], 0 offen offset:0 nt
    buffer_load_dwordx2 v[24:25], v5, s[52:55], 0 offen offset:2048 nt
    s_setprio 2
    buffer_load_dwordx2 v[26:27], v5, s[52:55], s60 offen offset:0 nt
    buffer_load_dwordx2 v[28:29], v5, s[52:55], s60 offen offset:2048 nt
    buffer_load_dwordx2 v[30:31], v5, s[52:55], s61 offen offset:0 nt
    buffer_load_dwordx2 v[32:33], v5, s[52:55], s61 offen offset:2048 nt
    buffer_load_dwordx2 v[34:35], v5, s[52:55], s62 offen offset:0 nt
    buffer_load_dwordx2 v[36:37], v5, s[52:55], s62 offen offset:2048 nt
    s_setprio 1
    buffer_load_dwordx2 v[38:39], v5, s[56:59], 0 offen offset:0 nt
    buffer_load_dwordx2 v[40:41], v5, s[56:59], 0 offen offset:2048 nt
    buffer_load_dwordx2 v[42:43], v5, s[56:59], s60 offen offset:0 nt
    buffer_load_dwordx2 v[44:45], v5, s[56:59], s60 offen offset:2048 nt
    s_setprio 0
    buffer_load_dwordx2 v[46:47], v5, s[56:59], s61 offen offset:0 nt
    buffer_load_dwordx2 v[48:49], v5, s[56:59], s61 offen offset:2048 nt
    buffer_load_dwordx2 v[50:51], v5, s[56:59], s62 offen offset:0 nt
    buffer_load_dwordx2 v[52:53], v5, s[56:59], s62 offen offset:2048 nt
    s_mov_b64 exec, 1
    ds_add_u32 v14, v15 offset:80
    s_mov_b64 exec, -1
    s_lshl_b32 s69, s33, 21
    s_lshr_b32 s16, s35, 1
    s_lshl_b32 s16, s16, 7
    s_and_b32 s17, s35, 1
    s_lshl_b32 s17, s17, 4
    s_add_u32 s16, s16, s17
    s_lshl_b32 s17, s36, 5
    s_add_u32 s17, s17, s16
    s_lshl_b32 s48, s17, 11
    s_lshl_b32 s49, s33, 8
    s_add_u32 s48, s48, s49
    s_add_u32 s44, s26, s48
    s_addc_u32 s45, s27, 0
    s_mov_b32 s46, 30976
    s_mov_b32 s47, 0x20000
    v_and_b32 v8, 15, v1
    v_lshrrev_b32 v9, 4, v1
    s_lshl_b32 s50, s17, 11
    s_lshl_b32 s49, s33, 8
    v_lshl_add_u32 v10, v8, 4, s49
    v_lshl_add_u32 v204, v9, 12, v10
    v_add_u32 v204, s50, v204
    v_add_u32 v205, 16384, v204
    v_sub_u32 v11, 7, v4
    v_and_b32 v12, 7, v3
    v_xor_b32 v11, v11, v12
    v_lshlrev_b32 v11, 4, v11
    v_lshl_add_u32 v11, v3, 9, v11
    v_add_u32 v11, 70400, v11
    v_and_b32 v3, 7, v0
    v_xor_b32 v12, v3, v4
    v_lshlrev_b32 v12, 4, v12
    v_lshrrev_b32 v5, 3, v0
    v_lshl_add_u32 v12, v5, 7, v12
    v_add_u32 v12, 70400, v12
    s_sub_u32 s49, 31, s35
    s_lshl_b32 s49, s49, 7
    v_lshlrev_b32 v13, 12, v5
    v_lshl_add_u32 v13, v3, 4, v13
    v_add_u32 v13, s49, v13
    v_and_b32 v182, 1, v3
    v_lshlrev_b32 v182, 13, v182
    v_lshrrev_b32 v2, 2, v3
    v_lshl_add_u32 v182, v2, 12, v182
    v_lshl_add_u32 v182, v5, 7, v182
    s_sub_u32 s49, 31, s35
    s_and_b32 s48, s49, 7
    s_lshl_b32 s48, s48, 4
    s_lshr_b32 s49, s49, 3
    s_lshl_b32 s49, s49, 2
    s_add_u32 s48, s48, s49
    v_add_u32 v182, s48, v182
    s_sub_u32 s49, 31, s35
    s_lshr_b32 s48, s49, 1
    s_lshl_b32 s48, s48, 11
    s_and_b32 s49, s49, 1
    s_lshl_b32 s49, s49, 7
    s_add_u32 s48, s48, s49
    s_lshl_b32 s49, s33, 8
    s_add_u32 s48, s48, s49
    v_lshrrev_b32 v13, 3, v5
    v_lshlrev_b32 v13, 18, v13
    v_bfe_u32 v2, v5, 2, 1
    v_lshl_add_u32 v13, v2, 15, v13
    v_and_b32 v2, 3, v5
    v_lshl_add_u32 v13, v2, 16, v13
    v_lshl_add_u32 v13, v3, 4, v13
    v_add_u32 v13, s48, v13
    s_add_u32 s48, s69, 1572864
    v_add_u32 v182, s48, v182
    v_bfe_u32 v2, v8, 2, 1
    v_lshlrev_b32 v2, 3, v2
    v_lshrrev_b32 v3, 3, v8
    v_lshl_add_u32 v206, v9, 1, v2
    v_add_u32 v206, v206, v3
    v_lshl_add_u32 v2, v3, 2, v2
    v_add_u32 v2, v2, v9
    s_lshl_b32 s48, s35, 13
    s_lshl_b32 s49, s32, 11
    s_add_u32 s48, s48, s49
    s_add_u32 s48, s48, 16777216
    v_lshl_add_u32 v177, v1, 4, s48
    s_lshl_b32 s49, s33, 8
    s_add_u32 s68, s48, s49
    v_lshl_add_u32 v176, v2, 4, s68
    v_lshlrev_b32 v2, 3, v3
    v_and_b32 v3, 3, v8
    v_lshl_add_u32 v2, v3, 1, v2
    v_bfe_u32 v3, v8, 2, 1
    v_add_u32 v2, v2, v3
    s_sub_u32 s48, 2047, s17
    v_sub_u32 v178, s48, v2
    s_lshl_b32 s48, s32, 7
    s_add_u32 s48, s48, 153344
    v_lshl_add_u32 v206, v206, 3, s48
    v_lshl_add_u32 v207, v8, 3, s48
    s_mov_b32 s40, 0x3f803f80
    s_mov_b32 s41, 0x00003f80
    s_mov_b32 s42, 0x3f800000
    s_mov_b32 s66, 0x11111111
    s_mov_b32 s67, 0x11111111
    s_movk_i32 s65, 0xf800
    v_lshlrev_b32 v246, 11, v9
    v_lshl_add_u32 v246, v8, 4, v246
    s_movk_i32 s51, 0x2000
    s_movk_i32 s70, 0x4000
    s_movk_i32 s71, 0x6000
    s_lshl_b32 s64, s32, 12
    s_add_u32 s64, s64, 135936
    v_lshrrev_b32 v2, 2, v8
    v_lshl_add_u32 v2, v9, 3, v2
    v_lshlrev_b32 v2, 7, v2
    v_bfe_u32 v3, v8, 1, 1
    v_lshl_add_u32 v2, v3, 6, v2
    v_and_b32 v3, 1, v8
    v_lshl_add_u32 v2, v3, 3, v2
    v_and_b32 v3, 1, v9
    v_lshlrev_b32 v3, 1, v3
    v_lshrrev_b32 v174, 3, v8
    v_or_b32 v3, v3, v174
    v_xor_b32 v3, s32, v3
    v_lshl_add_u32 v2, v3, 4, v2
    v_add_u32 v174, 135936, v2
    v_lshl_add_u32 v175, v1, 4, s64
    v_xor_b32 v2, v8, v9
    v_lshl_add_u32 v2, v2, 4, s64
    v_lshl_add_u32 v247, v9, 8, v2
    v_lshl_add_u32 v251, v8, 8, v2
    v_xor_b32 v248, 64, v247
    v_xor_b32 v252, 64, v251
    v_xor_b32 v249, 128, v247
    v_xor_b32 v253, 128, v251
    v_xor_b32 v250, 192, v247
    v_xor_b32 v254, 192, v251
    s_lshl_b32 s48, s35, 9
    s_add_u32 s48, s48, s69
    s_add_u32 s48, s48, 1703936
    v_lshl_add_u32 v180, v1, 4, s48
    v_lshlrev_b32 v181, 3, v1
    v_add_u32 v181, 160768, v181
    s_mul_i32 s48, s33, 917504
    s_lshl_b32 s49, s35, 8
    s_add_u32 s48, s48, s49
    s_add_u32 s52, s20, s48
    s_addc_u32 s53, s21, 0
    s_add_u32 s56, s22, s48
    s_addc_u32 s57, s23, 0
    s_cmp_lt_u32 s35, 28
    s_cselect_b32 s54, 910592, 0
    s_mov_b32 s58, s54
    s_cselect_b32 s62, 260352, 0
    s_mov_b32 s63, 0x20000
    s_min_u32 s48, s35, 27
    s_lshl_b32 s48, s48, 18
    s_lshl_b32 s49, s33, 8
    s_add_u32 s48, s48, s49
    s_add_u32 s60, s24, s48
    s_addc_u32 s61, s25, 0
    v_lshlrev_b32 v2, 1, v9
    v_xor_b32 v2, v2, v8
    v_lshlrev_b32 v2, 4, v2
    s_lshl_b32 s48, s36, 5
    v_add_u32 v3, s48, v9
    v_mul_u32_u24 v240, 7168, v3
    v_add_u32 v240, v240, v2
    v_xor_b32 v241, 128, v240
    s_lshl_b32 s48, s36, 2
    v_add_u32 v3, s48, v9
    v_lshl_add_u32 v242, v3, 11, v2
    s_lshr_b32 s48, s36, 1
    s_xor_b32 s48, s48, s36
    s_and_b32 s48, s48, 1
    s_lshl_b32 s48, s48, 7
    v_xor_b32 v242, s48, v242
    s_lshl_b32 s48, s36, 10
    v_lshl_add_u32 v244, v1, 4, s48
    s_lshl_b32 s48, s36, 13
    s_add_u32 s48, s48, 70400
    v_lshl_add_u32 v245, v1, 4, s48
    s_getreg_b32 s3, hwreg(HW_REG_XCC_ID, 0, 4)
    s_lshl_b32 s3, s3, 28
    s_waitcnt lgkmcnt(0)
    s_add_u32 s38, s38, 1
    s_mul_i32 s43, s38, 0x9e3779b1
    s_add_u32 s43, s43, 0x7f4a7c15
    s_xor_b32 s43, s43, s3
    s_waitcnt vmcnt(19)
    v_lshlrev_b32 v62, 16, v54
    v_and_b32 v64, s34, v54
    v_lshlrev_b32 v66, 16, v55
    v_and_b32 v68, s34, v55
    v_lshlrev_b32 v63, 16, v56
    v_and_b32 v65, s34, v56
    v_lshlrev_b32 v67, 16, v57
    v_and_b32 v69, s34, v57
    v_lshlrev_b32 v70, 16, v58
    v_and_b32 v72, s34, v58
    v_lshlrev_b32 v74, 16, v59
    v_and_b32 v76, s34, v59
    v_lshlrev_b32 v71, 16, v60
    v_and_b32 v73, s34, v60
    v_lshlrev_b32 v75, 16, v61
    v_and_b32 v77, s34, v61
    s_waitcnt vmcnt(18)
    v_lshlrev_b32 v78, 16, v16
    v_and_b32 v79, s34, v16
    v_lshlrev_b32 v80, 16, v17
    v_and_b32 v81, s34, v17
    s_waitcnt vmcnt(17)
    v_lshlrev_b32 v82, 16, v18
    v_and_b32 v83, s34, v18
    v_lshlrev_b32 v84, 16, v19
    v_and_b32 v85, s34, v19
    s_waitcnt vmcnt(16)
    v_lshlrev_b32 v86, 16, v20
    v_and_b32 v87, s34, v20
    v_lshlrev_b32 v88, 16, v21
    v_and_b32 v89, s34, v21
    s_waitcnt vmcnt(15)
    v_lshlrev_b32 v90, 16, v22
    v_and_b32 v91, s34, v22
    v_lshlrev_b32 v92, 16, v23
    v_and_b32 v93, s34, v23
    v_pk_mul_f32 v[122:123], v[78:79], v[68:69]
    v_pk_fma_f32 v[122:123], v[82:83], v[66:67], v[122:123]
    v_pk_fma_f32 v[122:123], v[86:87], v[64:65], v[122:123]
    v_pk_fma_f32 v[122:123], v[90:91], v[62:63], v[122:123]
    v_pk_mul_f32 v[124:125], v[80:81], v[76:77]
    v_pk_fma_f32 v[124:125], v[84:85], v[74:75], v[124:125]
    v_pk_fma_f32 v[124:125], v[88:89], v[72:73], v[124:125]
    v_pk_fma_f32 v[124:125], v[92:93], v[70:71], v[124:125]
    s_waitcnt vmcnt(14)
    v_lshlrev_b32 v94, 16, v24
    v_and_b32 v95, s34, v24
    v_lshlrev_b32 v96, 16, v25
    v_and_b32 v97, s34, v25
    v_pk_mul_f32 v[126:127], v[82:83], v[68:69]
    v_pk_fma_f32 v[126:127], v[86:87], v[66:67], v[126:127]
    v_pk_fma_f32 v[126:127], v[90:91], v[64:65], v[126:127]
    v_pk_fma_f32 v[126:127], v[94:95], v[62:63], v[126:127]
    v_pk_mul_f32 v[128:129], v[84:85], v[76:77]
    v_pk_fma_f32 v[128:129], v[88:89], v[74:75], v[128:129]
    v_pk_fma_f32 v[128:129], v[92:93], v[72:73], v[128:129]
    v_pk_fma_f32 v[128:129], v[96:97], v[70:71], v[128:129]
    s_waitcnt vmcnt(13)
    v_lshlrev_b32 v98, 16, v26
    v_and_b32 v99, s34, v26
    v_lshlrev_b32 v100, 16, v27
    v_and_b32 v101, s34, v27
    v_pk_mul_f32 v[130:131], v[86:87], v[68:69]
    v_pk_fma_f32 v[130:131], v[90:91], v[66:67], v[130:131]
    v_pk_fma_f32 v[130:131], v[94:95], v[64:65], v[130:131]
    v_pk_fma_f32 v[130:131], v[98:99], v[62:63], v[130:131]
    v_pk_mul_f32 v[132:133], v[88:89], v[76:77]
    v_pk_fma_f32 v[132:133], v[92:93], v[74:75], v[132:133]
    v_pk_fma_f32 v[132:133], v[96:97], v[72:73], v[132:133]
    v_pk_fma_f32 v[132:133], v[100:101], v[70:71], v[132:133]
    s_waitcnt vmcnt(12)
    v_lshlrev_b32 v102, 16, v28
    v_and_b32 v103, s34, v28
    v_lshlrev_b32 v104, 16, v29
    v_and_b32 v105, s34, v29
    v_pk_mul_f32 v[134:135], v[90:91], v[68:69]
    v_pk_fma_f32 v[134:135], v[94:95], v[66:67], v[134:135]
    v_pk_fma_f32 v[134:135], v[98:99], v[64:65], v[134:135]
    v_pk_fma_f32 v[134:135], v[102:103], v[62:63], v[134:135]
    v_pk_mul_f32 v[136:137], v[92:93], v[76:77]
    v_pk_fma_f32 v[136:137], v[96:97], v[74:75], v[136:137]
    v_pk_fma_f32 v[136:137], v[100:101], v[72:73], v[136:137]
    v_pk_fma_f32 v[136:137], v[104:105], v[70:71], v[136:137]
    s_waitcnt vmcnt(11)
    v_lshlrev_b32 v106, 16, v30
    v_and_b32 v107, s34, v30
    v_lshlrev_b32 v108, 16, v31
    v_and_b32 v109, s34, v31
    v_pk_mul_f32 v[138:139], v[94:95], v[68:69]
    v_pk_fma_f32 v[138:139], v[98:99], v[66:67], v[138:139]
    v_pk_fma_f32 v[138:139], v[102:103], v[64:65], v[138:139]
    v_pk_fma_f32 v[138:139], v[106:107], v[62:63], v[138:139]
    v_pk_mul_f32 v[140:141], v[96:97], v[76:77]
    v_pk_fma_f32 v[140:141], v[100:101], v[74:75], v[140:141]
    v_pk_fma_f32 v[140:141], v[104:105], v[72:73], v[140:141]
    v_pk_fma_f32 v[140:141], v[108:109], v[70:71], v[140:141]
    s_waitcnt vmcnt(10)
    v_lshlrev_b32 v110, 16, v32
    v_and_b32 v111, s34, v32
    v_lshlrev_b32 v112, 16, v33
    v_and_b32 v113, s34, v33
    v_pk_mul_f32 v[142:143], v[98:99], v[68:69]
    v_pk_fma_f32 v[142:143], v[102:103], v[66:67], v[142:143]
    v_pk_fma_f32 v[142:143], v[106:107], v[64:65], v[142:143]
    v_pk_fma_f32 v[142:143], v[110:111], v[62:63], v[142:143]
    v_pk_mul_f32 v[144:145], v[100:101], v[76:77]
    v_pk_fma_f32 v[144:145], v[104:105], v[74:75], v[144:145]
    v_pk_fma_f32 v[144:145], v[108:109], v[72:73], v[144:145]
    v_pk_fma_f32 v[144:145], v[112:113], v[70:71], v[144:145]
    s_waitcnt vmcnt(9)
    v_lshlrev_b32 v114, 16, v34
    v_and_b32 v115, s34, v34
    v_lshlrev_b32 v116, 16, v35
    v_and_b32 v117, s34, v35
    v_pk_mul_f32 v[146:147], v[102:103], v[68:69]
    v_pk_fma_f32 v[146:147], v[106:107], v[66:67], v[146:147]
    v_pk_fma_f32 v[146:147], v[110:111], v[64:65], v[146:147]
    v_pk_fma_f32 v[146:147], v[114:115], v[62:63], v[146:147]
    v_pk_mul_f32 v[148:149], v[104:105], v[76:77]
    v_pk_fma_f32 v[148:149], v[108:109], v[74:75], v[148:149]
    v_pk_fma_f32 v[148:149], v[112:113], v[72:73], v[148:149]
    v_pk_fma_f32 v[148:149], v[116:117], v[70:71], v[148:149]
    s_waitcnt vmcnt(8)
    v_lshlrev_b32 v118, 16, v36
    v_and_b32 v119, s34, v36
    v_lshlrev_b32 v120, 16, v37
    v_and_b32 v121, s34, v37
    v_pk_mul_f32 v[150:151], v[106:107], v[68:69]
    v_pk_fma_f32 v[150:151], v[110:111], v[66:67], v[150:151]
    v_pk_fma_f32 v[150:151], v[114:115], v[64:65], v[150:151]
    v_pk_fma_f32 v[150:151], v[118:119], v[62:63], v[150:151]
    v_pk_mul_f32 v[152:153], v[108:109], v[76:77]
    v_pk_fma_f32 v[152:153], v[112:113], v[74:75], v[152:153]
    v_pk_fma_f32 v[152:153], v[116:117], v[72:73], v[152:153]
    v_pk_fma_f32 v[152:153], v[120:121], v[70:71], v[152:153]
    s_waitcnt vmcnt(7)
    v_lshlrev_b32 v154, 16, v38
    v_and_b32 v155, s34, v38
    v_pk_mul_f32 v[122:123], v[122:123], v[154:155]
    v_lshlrev_b32 v156, 16, v39
    v_and_b32 v157, s34, v39
    v_pk_mul_f32 v[124:125], v[124:125], v[156:157]
    s_waitcnt vmcnt(6)
    v_lshlrev_b32 v154, 16, v40
    v_and_b32 v155, s34, v40
    v_pk_mul_f32 v[126:127], v[126:127], v[154:155]
    v_lshlrev_b32 v156, 16, v41
    v_and_b32 v157, s34, v41
    v_pk_mul_f32 v[128:129], v[128:129], v[156:157]
    v_cvt_pk_bf16_f32 v161, v126, v122
    v_cvt_pk_bf16_f32 v165, v127, v123
    v_cvt_pk_bf16_f32 v169, v128, v124
    v_cvt_pk_bf16_f32 v173, v129, v125
    s_waitcnt vmcnt(5)
    v_lshlrev_b32 v154, 16, v42
    v_and_b32 v155, s34, v42
    v_pk_mul_f32 v[130:131], v[130:131], v[154:155]
    v_lshlrev_b32 v156, 16, v43
    v_and_b32 v157, s34, v43
    v_pk_mul_f32 v[132:133], v[132:133], v[156:157]
    s_waitcnt vmcnt(4)
    v_lshlrev_b32 v154, 16, v44
    v_and_b32 v155, s34, v44
    v_pk_mul_f32 v[134:135], v[134:135], v[154:155]
    v_lshlrev_b32 v156, 16, v45
    v_and_b32 v157, s34, v45
    v_pk_mul_f32 v[136:137], v[136:137], v[156:157]
    v_cvt_pk_bf16_f32 v160, v134, v130
    v_cvt_pk_bf16_f32 v164, v135, v131
    v_cvt_pk_bf16_f32 v168, v136, v132
    v_cvt_pk_bf16_f32 v172, v137, v133
    s_waitcnt vmcnt(3)
    v_lshlrev_b32 v154, 16, v46
    v_and_b32 v155, s34, v46
    v_pk_mul_f32 v[138:139], v[138:139], v[154:155]
    v_lshlrev_b32 v156, 16, v47
    v_and_b32 v157, s34, v47
    v_pk_mul_f32 v[140:141], v[140:141], v[156:157]
    s_waitcnt vmcnt(2)
    v_lshlrev_b32 v154, 16, v48
    v_and_b32 v155, s34, v48
    v_pk_mul_f32 v[142:143], v[142:143], v[154:155]
    v_lshlrev_b32 v156, 16, v49
    v_and_b32 v157, s34, v49
    v_pk_mul_f32 v[144:145], v[144:145], v[156:157]
    v_cvt_pk_bf16_f32 v159, v142, v138
    v_cvt_pk_bf16_f32 v163, v143, v139
    v_cvt_pk_bf16_f32 v167, v144, v140
    v_cvt_pk_bf16_f32 v171, v145, v141
    s_waitcnt vmcnt(1)
    v_lshlrev_b32 v154, 16, v50
    v_and_b32 v155, s34, v50
    v_pk_mul_f32 v[146:147], v[146:147], v[154:155]
    v_lshlrev_b32 v156, 16, v51
    v_and_b32 v157, s34, v51
    v_pk_mul_f32 v[148:149], v[148:149], v[156:157]
    s_waitcnt vmcnt(0)
    global_load_dwordx4 v[184:187], v204, s[4:5] offset:0 nt
    global_load_dwordx4 v[188:191], v204, s[4:5] offset:2048 nt
    global_load_dwordx4 v[192:195], v205, s[4:5] offset:0 nt
    global_load_dwordx4 v[196:199], v205, s[4:5] offset:2048 nt
    global_load_dwordx4 v[200:203], v10, s[18:19]
    v_lshlrev_b32 v154, 16, v52
    v_and_b32 v155, s34, v52
    v_pk_mul_f32 v[150:151], v[150:151], v[154:155]
    v_lshlrev_b32 v156, 16, v53
    v_and_b32 v157, s34, v53
    v_pk_mul_f32 v[152:153], v[152:153], v[156:157]
    v_cvt_pk_bf16_f32 v158, v150, v146
    v_cvt_pk_bf16_f32 v162, v151, v147
    v_cvt_pk_bf16_f32 v166, v152, v148
    v_cvt_pk_bf16_f32 v170, v153, v149
    ds_write_b128 v11, v[158:161] offset:0
    ds_write_b128 v11, v[162:165] offset:128
    ds_write_b128 v11, v[166:169] offset:256
    ds_write_b128 v11, v[170:173] offset:384
    s_mov_b64 exec, 1
    ds_add_u32 v14, v15 offset:0
    s_mov_b64 exec, -1
    s_mov_b32 s48, 0
H_stg:
    ds_read_b32 v6, v14 offset:0
    s_add_u32 s48, s48, 1
    s_waitcnt lgkmcnt(0)
    v_cmp_gt_u32 vcc, 4, v6
    s_cbranch_vccz H_stg_d
    s_cmp_ge_u32 s48, 2000000
    s_cbranch_scc1 H_stg_d
    s_branch H_stg
H_stg_d:
    ds_read_b128 v[16:19], v12 offset:0
    ds_read_b128 v[20:23], v12 offset:4096
    ds_read_b128 v[24:27], v12 offset:8192
    ds_read_b128 v[28:31], v12 offset:12288
    s_waitcnt lgkmcnt(3)
    global_store_dwordx4 v13, v[16:19], s[26:27]
    v_add_u32 v13, 0x100000, v13
    s_waitcnt lgkmcnt(2)
    global_store_dwordx4 v13, v[20:23], s[26:27]
    v_add_u32 v13, 0x100000, v13
    s_waitcnt lgkmcnt(1)
    global_store_dwordx4 v13, v[24:27], s[26:27]
    v_add_u32 v13, 0x100000, v13
    s_waitcnt lgkmcnt(0)
    global_store_dwordx4 v13, v[28:31], s[26:27]
    s_mov_b32 s48, 0xaaaaaaaa
    s_mov_b32 s49, 0xaaaaaaaa
    v_alignbit_b32 v32, v19, v19, 9
    v_alignbit_b32 v33, v23, v23, 9
    v_alignbit_b32 v34, v27, v27, 9
    v_alignbit_b32 v35, v31, v31, 9
    v_add3_u32 v32, v16, v17, v32
    v_add3_u32 v33, v20, v21, v33
    v_add3_u32 v34, v24, v25, v34
    v_add3_u32 v35, v28, v29, v35
    v_add_u32 v32, v18, v32
    v_add_u32 v33, v22, v33
    v_add_u32 v34, v26, v34
    v_add_u32 v35, v30, v35
    v_add_u32_dpp v32, v32, v32 row_half_mirror row_mask:0xf bank_mask:0x5
    v_add_u32_dpp v34, v34, v34 row_half_mirror row_mask:0xf bank_mask:0x5
    s_nop 0
    v_add_u32_dpp v32, v33, v33 row_half_mirror row_mask:0xf bank_mask:0xa
    v_add_u32_dpp v34, v35, v35 row_half_mirror row_mask:0xf bank_mask:0xa
    s_nop 0
    v_add_u32_dpp v32, v32, v32 quad_perm:[2,3,0,1] row_mask:0xf bank_mask:0xf
    v_add_u32_dpp v34, v34, v34 quad_perm:[2,3,0,1] row_mask:0xf bank_mask:0xf
    s_nop 0
    v_add_u32_dpp v32, v32, v32 quad_perm:[1,0,3,2] row_mask:0xf bank_mask:0xf
    v_add_u32_dpp v34, v34, v34 quad_perm:[1,0,3,2] row_mask:0xf bank_mask:0xf
    v_cndmask_b32 v32, v32, v34, s[48:49]
    s_mov_b32 exec_lo, 0x33333333
    s_mov_b32 exec_hi, 0x33333333
    v_xor_b32 v32, s43, v32
    global_store_dword v182, v32, s[30:31]
    s_mov_b64 exec, -1
    s_mov_b64 exec, 1
    ds_add_u32 v14, v15 offset:4
    s_mov_b64 exec, -1
    v_mov_b32 v143, s38
    v_and_b32 v2, 7, v1
    v_mul_u32_u24 v2, 240, v2
    v_lshrrev_b32 v3, 3, v1
    v_mul_u32_u24 v3, 112, v3
    v_add_u32 v183, v177, v2
    v_sub_u32 v183, v183, v3
    v_mov_b32 v68, -1
    v_mov_b32 v69, -1
    v_mov_b32 v70, -1
    v_mov_b32 v71, -1
    s_lshl_b32 s48, s33, 5
    v_and_b32 v2, 7, v1
    v_lshl_add_u32 v74, v2, 2, s48
    v_mov_b32 v75, s37
    s_waitcnt vmcnt(9)
    v_lshlrev_b32 v36, 16, v184
    v_and_b32 v37, s34, v184
    v_lshlrev_b32 v38, 16, v185
    v_and_b32 v39, s34, v185
    v_lshlrev_b32 v40, 16, v186
    v_and_b32 v41, s34, v186
    v_lshlrev_b32 v42, 16, v187
    v_and_b32 v43, s34, v187
    v_add_f32 v148, v36, v37
    v_mul_f32 v152, v36, v36
    v_fmac_f32 v152, v37, v37
    v_add_f32 v148, v148, v38
    v_fmac_f32 v152, v38, v38
    v_add_f32 v148, v148, v39
    v_fmac_f32 v152, v39, v39
    v_add_f32 v148, v148, v40
    v_fmac_f32 v152, v40, v40
    v_add_f32 v148, v148, v41
    v_fmac_f32 v152, v41, v41
    v_add_f32 v148, v148, v42
    v_fmac_f32 v152, v42, v42
    v_add_f32 v148, v148, v43
    v_fmac_f32 v152, v43, v43
    s_waitcnt vmcnt(8)
    v_lshlrev_b32 v44, 16, v188
    v_and_b32 v45, s34, v188
    v_lshlrev_b32 v46, 16, v189
    v_and_b32 v47, s34, v189
    v_lshlrev_b32 v48, 16, v190
    v_and_b32 v49, s34, v190
    v_lshlrev_b32 v50, 16, v191
    v_and_b32 v51, s34, v191
    v_add_f32 v149, v44, v45
    v_mul_f32 v153, v44, v44
    v_fmac_f32 v153, v45, v45
    v_add_f32 v149, v149, v46
    v_fmac_f32 v153, v46, v46
    v_add_f32 v149, v149, v47
    v_fmac_f32 v153, v47, v47
    v_add_f32 v149, v149, v48
    v_fmac_f32 v153, v48, v48
    v_add_f32 v149, v149, v49
    v_fmac_f32 v153, v49, v49
    v_add_f32 v149, v149, v50
    v_fmac_f32 v153, v50, v50
    v_add_f32 v149, v149, v51
    v_fmac_f32 v153, v51, v51
    s_waitcnt vmcnt(7)
    v_lshlrev_b32 v52, 16, v192
    v_and_b32 v53, s34, v192
    v_lshlrev_b32 v54, 16, v193
    v_and_b32 v55, s34, v193
    v_lshlrev_b32 v56, 16, v194
    v_and_b32 v57, s34, v194
    v_lshlrev_b32 v58, 16, v195
    v_and_b32 v59, s34, v195
    v_add_f32 v150, v52, v53
    v_mul_f32 v154, v52, v52
    v_fmac_f32 v154, v53, v53
    v_add_f32 v150, v150, v54
    v_fmac_f32 v154, v54, v54
    v_add_f32 v150, v150, v55
    v_fmac_f32 v154, v55, v55
    v_add_f32 v150, v150, v56
    v_fmac_f32 v154, v56, v56
    v_add_f32 v150, v150, v57
    v_fmac_f32 v154, v57, v57
    v_add_f32 v150, v150, v58
    v_fmac_f32 v154, v58, v58
    v_add_f32 v150, v150, v59
    v_fmac_f32 v154, v59, v59
    s_waitcnt vmcnt(6)
    v_lshlrev_b32 v60, 16, v196
    v_and_b32 v61, s34, v196
    v_lshlrev_b32 v62, 16, v197
    v_and_b32 v63, s34, v197
    v_lshlrev_b32 v64, 16, v198
    v_and_b32 v65, s34, v198
    v_lshlrev_b32 v66, 16, v199
    v_and_b32 v67, s34, v199
    v_add_f32 v151, v60, v61
    v_mul_f32 v155, v60, v60
    v_fmac_f32 v155, v61, v61
    v_add_f32 v151, v151, v62
    v_fmac_f32 v155, v62, v62
    v_add_f32 v151, v151, v63
    v_fmac_f32 v155, v63, v63
    v_add_f32 v151, v151, v64
    v_fmac_f32 v155, v64, v64
    v_add_f32 v151, v151, v65
    v_fmac_f32 v155, v65, v65
    v_add_f32 v151, v151, v66
    v_fmac_f32 v155, v66, v66
    v_add_f32 v151, v151, v67
    v_fmac_f32 v155, v67, v67
    s_waitcnt vmcnt(5)
    v_lshlrev_b32 v132, 16, v200
    v_and_b32 v133, s34, v200
    v_lshlrev_b32 v134, 16, v201
    v_and_b32 v135, s34, v201
    v_lshlrev_b32 v136, 16, v202
    v_and_b32 v137, s34, v202
    v_lshlrev_b32 v138, 16, v203
    v_and_b32 v139, s34, v203
    v_add_f32 v156, v132, v133
    v_add_f32 v156, v156, v134
    v_add_f32 v156, v156, v135
    v_add_f32 v156, v156, v136
    v_add_f32 v156, v156, v137
    v_add_f32 v156, v156, v138
    v_add_f32 v156, v156, v139
    v_add_f32_dpp v148, v148, v148 row_ror:8 row_mask:0xf bank_mask:0x3
    v_add_f32_dpp v150, v150, v150 row_ror:8 row_mask:0xf bank_mask:0x3
    v_add_f32_dpp v152, v152, v152 row_ror:8 row_mask:0xf bank_mask:0x3
    v_add_f32_dpp v154, v154, v154 row_ror:8 row_mask:0xf bank_mask:0x3
    v_add_f32_dpp v156, v156, v156 row_ror:8 row_mask:0xf bank_mask:0xf
    v_add_f32_dpp v148, v149, v149 row_ror:8 row_mask:0xf bank_mask:0xc
    v_add_f32_dpp v150, v151, v151 row_ror:8 row_mask:0xf bank_mask:0xc
    v_add_f32_dpp v152, v153, v153 row_ror:8 row_mask:0xf bank_mask:0xc
    v_add_f32_dpp v154, v155, v155 row_ror:8 row_mask:0xf bank_mask:0xc
    v_add_f32_dpp v148, v148, v148 row_half_mirror row_mask:0xf bank_mask:0x5
    v_add_f32_dpp v152, v152, v152 row_half_mirror row_mask:0xf bank_mask:0x5
    v_add_f32_dpp v156, v156, v156 row_half_mirror row_mask:0xf bank_mask:0xf
    v_add_f32_dpp v148, v150, v150 row_half_mirror row_mask:0xf bank_mask:0xa
    v_add_f32_dpp v152, v154, v154 row_half_mirror row_mask:0xf bank_mask:0xa
    s_nop 0
    v_add_f32_dpp v148, v148, v148 quad_perm:[2,3,0,1] row_mask:0xf bank_mask:0xf
    v_add_f32_dpp v152, v152, v152 quad_perm:[2,3,0,1] row_mask:0xf bank_mask:0xf
    v_add_f32_dpp v156, v156, v156 quad_perm:[2,3,0,1] row_mask:0xf bank_mask:0xf
    v_add_f32_dpp v140, v148, v148 quad_perm:[1,0,3,2] row_mask:0xf bank_mask:0xf
    v_add_f32_dpp v141, v152, v152 quad_perm:[1,0,3,2] row_mask:0xf bank_mask:0xf
    v_add_f32_dpp v142, v156, v156 quad_perm:[1,0,3,2] row_mask:0xf bank_mask:0xf
    s_mov_b64 exec, s[66:67]
    global_store_dwordx4 v176, v[140:143], s[30:31] sc1
    s_mov_b64 exec, -1
    ds_write_b128 v247, v[184:187] offset:0
    ds_write_b128 v248, v[188:191] offset:1024
    ds_write_b128 v249, v[192:195] offset:2048
    ds_write_b128 v250, v[196:199] offset:3072
    v_mov_b32 v132, s40
    v_mov_b32 v133, s40
    v_mov_b32 v134, s40
    v_mov_b32 v135, s40
    v_cmp_eq_u32 vcc, 2, v9
    s_nop 1
    v_cndmask_b32 v132, v132, v200, vcc
    v_cndmask_b32 v133, v133, v201, vcc
    v_cndmask_b32 v134, v134, v202, vcc
    v_cndmask_b32 v135, v135, v203, vcc
    v_and_b32 v2, 1, v9
    v_cmp_eq_u32 vcc, 0, v2
    s_nop 1
    v_cndmask_b32 v132, 0, v132, vcc
    v_cndmask_b32 v133, 0, v133, vcc
    v_cndmask_b32 v134, 0, v134, vcc
    v_cndmask_b32 v135, 0, v135, vcc
    v_lshlrev_b32 v2, 4, v1
    v_add_u32 v2, 152320, v2
    ds_write_b128 v2, v[132:135]
    v_and_b32 v2, 3, v8
    v_lshlrev_b32 v2, 8, v2
    v_lshl_add_u32 v2, v9, 4, v2
    v_add_u32 v2, 152320, v2
    ds_read_b128 v[184:187], v251
    ds_read_b128 v[188:191], v252
    ds_read_b128 v[192:195], v253
    ds_read_b128 v[196:199], v254
    ds_read_b128 v[158:161], v2 offset:0
    ds_read_b128 v[162:165], v2 offset:64
    ds_read_b128 v[166:169], v2 offset:128
    ds_read_b128 v[170:173], v2 offset:192
    s_waitcnt lgkmcnt(7)
    v_lshlrev_b32 v36, 16, v184
    v_and_b32 v37, s34, v184
    v_lshlrev_b32 v38, 16, v185
    v_and_b32 v39, s34, v185
    v_lshlrev_b32 v40, 16, v186
    v_and_b32 v41, s34, v186
    v_lshlrev_b32 v42, 16, v187
    v_and_b32 v43, s34, v187
    s_waitcnt lgkmcnt(6)
    v_lshlrev_b32 v44, 16, v188
    v_and_b32 v45, s34, v188
    v_lshlrev_b32 v46, 16, v189
    v_and_b32 v47, s34, v189
    v_lshlrev_b32 v48, 16, v190
    v_and_b32 v49, s34, v190
    v_lshlrev_b32 v50, 16, v191
    v_and_b32 v51, s34, v191
    s_waitcnt lgkmcnt(5)
    v_lshlrev_b32 v52, 16, v192
    v_and_b32 v53, s34, v192
    v_lshlrev_b32 v54, 16, v193
    v_and_b32 v55, s34, v193
    v_lshlrev_b32 v56, 16, v194
    v_and_b32 v57, s34, v194
    v_lshlrev_b32 v58, 16, v195
    v_and_b32 v59, s34, v195
    s_waitcnt lgkmcnt(4)
    v_lshlrev_b32 v60, 16, v196
    v_and_b32 v61, s34, v196
    v_lshlrev_b32 v62, 16, v197
    v_and_b32 v63, s34, v197
    v_lshlrev_b32 v64, 16, v198
    v_and_b32 v65, s34, v198
    v_lshlrev_b32 v66, 16, v199
    v_and_b32 v67, s34, v199
    v_subrev_u32 v247, 135936, v247
    v_subrev_u32 v248, 135936, v248
    v_subrev_u32 v249, 135936, v249
    v_subrev_u32 v250, 135936, v250
    v_subrev_u32 v251, 135936, v251
    v_subrev_u32 v252, 135936, v252
    v_subrev_u32 v253, 135936, v253
    v_subrev_u32 v254, 135936, v254
    s_mov_b32 s48, 0
H_uld:
    ds_read_b64 v[6:7], v14 offset:8
    s_add_u32 s48, s48, 1
    s_waitcnt lgkmcnt(0)
    v_cmp_gt_u32 vcc, 4, v6
    s_cbranch_vccz H_uld_d
    s_cmp_ge_u32 s48, 2000000
    s_cbranch_scc1 H_uld_d
    s_branch H_uld
H_uld_d:
    global_store_dwordx4 v204, v[68:71], s[26:27] offset:0
    global_store_dwordx4 v204, v[68:71], s[26:27] offset:2048
    global_store_dwordx4 v205, v[68:71], s[26:27] offset:0
    global_store_dwordx4 v205, v[68:71], s[26:27] offset:2048
    v_readfirstlane_b32 s39, v7
    s_waitcnt vmcnt(0)
    s_mov_b64 exec, 1
    ds_add_rtn_u32 v2, v14, v15 offset:84
    s_waitcnt lgkmcnt(0)
    v_readfirstlane_b32 s48, v2
    s_cmp_lg_u32 s48, 3
    s_cbranch_scc1 H_nofl
    s_cmp_lg_u32 s39, 0
    s_cbranch_scc1 H_nofl
    global_store_byte v75, v68, s[28:29]
H_nofl:
    s_mov_b64 exec, -1
    s_mov_b32 s49, 0
    buffer_load_dwordx4 v[208:211], v240, s[56:59], s49 offen nt
    s_mov_b32 s49, 28672
    buffer_load_dwordx4 v[212:215], v241, s[56:59], s49 offen nt
    s_mov_b32 s49, 57344
    buffer_load_dwordx4 v[216:219], v241, s[56:59], s49 offen nt
    s_mov_b32 s49, 86016
    buffer_load_dwordx4 v[220:223], v240, s[56:59], s49 offen nt
    global_load_dwordx4 v[148:151], v183, s[30:31] sc1
    global_load_dwordx4 v[152:155], v183, s[30:31] offset:128 sc1
    s_mov_b32 s49, 114688
    buffer_load_dwordx4 v[224:227], v240, s[56:59], s49 offen nt
    s_mov_b32 s49, 143360
    buffer_load_dwordx4 v[228:231], v241, s[56:59], s49 offen nt
    s_mov_b32 s49, 172032
    buffer_load_dwordx4 v[232:235], v241, s[56:59], s49 offen nt
    s_mov_b32 s49, 200704
    buffer_load_dwordx4 v[236:239], v240, s[56:59], s49 offen nt
    s_mov_b32 s49, 0
    buffer_load_dwordx4 v[16:19], v240, s[52:55], s49 offen nt
    s_mov_b32 s49, 28672
    buffer_load_dwordx4 v[20:23], v241, s[52:55], s49 offen nt
    s_mov_b32 s49, 57344
    buffer_load_dwordx4 v[24:27], v241, s[52:55], s49 offen nt
    s_mov_b32 s49, 86016
    buffer_load_dwordx4 v[28:31], v240, s[52:55], s49 offen nt
    s_waitcnt vmcnt(8)
    v_xor_b32 v132, s38, v151
    v_bitop3_b32 v132, v155, s38, v132 bitop3:0xbe
    v_cmp_ne_u32 vcc, 0, v132
    s_cbranch_vccz H_p1_done
    s_mov_b32 s48, 0
H_p1_loop:
    global_load_dwordx4 v[148:151], v183, s[30:31] sc1
    global_load_dwordx4 v[152:155], v183, s[30:31] offset:128 sc1
    s_add_u32 s48, s48, 1
    s_waitcnt vmcnt(0)
    v_xor_b32 v132, s38, v151
    v_bitop3_b32 v132, v155, s38, v132 bitop3:0xbe
    v_cmp_ne_u32 vcc, 0, v132
    s_cbranch_vccz H_p1_done
    s_cmp_ge_u32 s48, 100000
    s_cbranch_scc1 H_p1_done
    s_sleep 2
    s_branch H_p1_loop
H_p1_done:
    v_add_f32_dpp v148, v148, v148 row_half_mirror row_mask:0xf bank_mask:0x5
    v_add_f32_dpp v149, v149, v149 row_half_mirror row_mask:0xf bank_mask:0x5
    v_add_f32_dpp v150, v150, v150 row_half_mirror row_mask:0xf bank_mask:0xf
    v_add_f32_dpp v148, v152, v152 row_half_mirror row_mask:0xf bank_mask:0xa
    v_add_f32_dpp v149, v153, v153 row_half_mirror row_mask:0xf bank_mask:0xa
    s_nop 0
    v_add_f32_dpp v148, v148, v148 quad_perm:[2,3,0,1] row_mask:0xf bank_mask:0xf
    v_add_f32_dpp v149, v149, v149 quad_perm:[2,3,0,1] row_mask:0xf bank_mask:0xf
    v_add_f32_dpp v150, v150, v150 quad_perm:[2,3,0,1] row_mask:0xf bank_mask:0xf
    v_add_f32_dpp v148, v148, v148 quad_perm:[1,0,3,2] row_mask:0xf bank_mask:0xf
    v_add_f32_dpp v149, v149, v149 quad_perm:[1,0,3,2] row_mask:0xf bank_mask:0xf
    v_add_f32_dpp v179, v150, v150 quad_perm:[1,0,3,2] row_mask:0xf bank_mask:0xf
    v_mul_f32 v132, 0x3a800000, v148
    v_mul_f32 v133, 0x3a800000, v149
    v_fma_f32 v133, -v132, v132, v133
    v_max_f32 v133, 0, v133
    v_cvt_pk_bf16_f32 v134, v132, v133
    v_and_b32 v133, s34, v134
    v_add_f32 v133, 0x3727c5ac, v133
    v_cvt_pk_bf16_f32 v133, v133, v133
    v_and_b32 v133, s34, v133
    v_sqrt_f32 v133, v133
    v_lshlrev_b32 v132, 16, v134
    v_cvt_pk_bf16_f32 v133, v133, v133
    v_and_b32 v133, s34, v133
    v_rcp_f32 v133, v133
    s_mov_b32 s49, 114688
    buffer_load_dwordx4 v[184:187], v240, s[52:55], s49 offen nt
    s_mov_b32 s49, 143360
    buffer_load_dwordx4 v[188:191], v241, s[52:55], s49 offen nt
    s_mov_b32 s49, 172032
    buffer_load_dwordx4 v[192:195], v241, s[52:55], s49 offen nt
    s_mov_b32 s49, 200704
    buffer_load_dwordx4 v[196:199], v240, s[52:55], s49 offen nt
    s_mov_b32 s49, 0
    buffer_load_dwordx4 v[100:103], v242, s[60:63], s49 offen nt
    ds_write_b64 v206, v[132:133]
    ds_read_b64 v[32:33], v207
    s_add_u32 s68, s68, 262144
    v_lshl_add_u32 v176, v8, 4, s68
    v_add_u32 v177, 262144, v177
    v_and_b32 v2, 3, v8
    v_cmp_eq_u32 s[56:57], 1, v2
    v_cmp_eq_u32 s[58:59], 2, v2
    v_cmp_eq_u32 s[60:61], 3, v2
    s_mov_b32 s66, 0x00f0000f
    s_mov_b32 s67, 0xf0000f00
    s_waitcnt lgkmcnt(0)
    v_mov_b32 v34, v33
    v_mov_b32 v35, v33
    v_mov_b32 v33, v32
    v_sub_f32 v68, v36, v32
    v_sub_f32 v69, v37, v32
    v_sub_f32 v70, v38, v32
    v_sub_f32 v71, v39, v32
    v_sub_f32 v72, v40, v32
    v_sub_f32 v73, v41, v32
    v_sub_f32 v74, v42, v32
    v_sub_f32 v75, v43, v32
    v_cvt_pk_bf16_f32 v136, v68, v69
    v_cvt_pk_bf16_f32 v137, v70, v71
    v_cvt_pk_bf16_f32 v138, v72, v73
    v_cvt_pk_bf16_f32 v139, v74, v75
    v_lshlrev_b32 v68, 16, v136
    v_and_b32 v69, s34, v136
    v_lshlrev_b32 v70, 16, v137
    v_and_b32 v71, s34, v137
    v_lshlrev_b32 v72, 16, v138
    v_and_b32 v73, s34, v138
    v_lshlrev_b32 v74, 16, v139
    v_and_b32 v75, s34, v139
    v_mul_f32 v68, v68, v34
    v_mul_f32 v69, v69, v34
    v_mul_f32 v70, v70, v34
    v_mul_f32 v71, v71, v34
    v_mul_f32 v72, v72, v34
    v_mul_f32 v73, v73, v34
    v_mul_f32 v74, v74, v34
    v_mul_f32 v75, v75, v34
    v_cvt_pk_bf16_f32 v136, v68, v69
    v_cvt_pk_bf16_f32 v137, v70, v71
    v_cvt_pk_bf16_f32 v138, v72, v73
    v_cvt_pk_bf16_f32 v139, v74, v75
    v_and_b32 v68, 0xffff, v136
    v_and_b32 v69, s34, v136
    v_and_b32 v70, 0xffff, v137
    v_and_b32 v71, s34, v137
    v_and_b32 v72, 0xffff, v138
    v_and_b32 v73, s34, v138
    v_and_b32 v74, 0xffff, v139
    v_and_b32 v75, s34, v139
    s_mov_b32 s48, 0
H_ms:
    ds_read_b32 v6, v14 offset:68
    s_add_u32 s48, s48, 1
    s_waitcnt lgkmcnt(0)
    v_cmp_gt_u32 vcc, 1, v6
    s_cbranch_vccz H_ms_d
    s_cmp_ge_u32 s48, 2000000
    s_cbranch_scc1 H_ms_d
    s_sleep 2
    s_branch H_ms
H_ms_d:
    s_setprio 2
    v_pk_add_f32 v[76:77], v[44:45], v[32:33] neg_lo:[0,1] neg_hi:[0,1]
    v_pk_add_f32 v[78:79], v[46:47], v[32:33] neg_lo:[0,1] neg_hi:[0,1]
    v_pk_add_f32 v[80:81], v[48:49], v[32:33] neg_lo:[0,1] neg_hi:[0,1]
    v_pk_add_f32 v[82:83], v[50:51], v[32:33] neg_lo:[0,1] neg_hi:[0,1]
    v_cvt_pk_bf16_f32 v136, v76, v77
    v_cvt_pk_bf16_f32 v137, v78, v79
    v_cvt_pk_bf16_f32 v138, v80, v81
    v_cvt_pk_bf16_f32 v139, v82, v83
    v_lshlrev_b32 v76, 16, v136
    v_and_b32 v77, s34, v136
    v_lshlrev_b32 v78, 16, v137
    v_and_b32 v79, s34, v137
    v_lshlrev_b32 v80, 16, v138
    v_and_b32 v81, s34, v138
    v_lshlrev_b32 v82, 16, v139
    v_and_b32 v83, s34, v139
    v_pk_mul_f32 v[76:77], v[76:77], v[34:35]
    v_pk_mul_f32 v[78:79], v[78:79], v[34:35]
    v_pk_mul_f32 v[80:81], v[80:81], v[34:35]
    v_pk_mul_f32 v[82:83], v[82:83], v[34:35]
    v_cvt_pk_bf16_f32 v136, v76, v77
    v_cvt_pk_bf16_f32 v137, v78, v79
    v_cvt_pk_bf16_f32 v138, v80, v81
    v_cvt_pk_bf16_f32 v139, v82, v83
    v_and_b32 v76, 0xffff, v136
    v_and_b32 v77, s34, v136
    v_and_b32 v78, 0xffff, v137
    v_and_b32 v79, s34, v137
    v_and_b32 v80, 0xffff, v138
    v_and_b32 v81, s34, v138
    v_and_b32 v82, 0xffff, v139
    v_and_b32 v83, s34, v139
    v_pk_add_f32 v[84:85], v[52:53], v[32:33] neg_lo:[0,1] neg_hi:[0,1]
    v_pk_add_f32 v[86:87], v[54:55], v[32:33] neg_lo:[0,1] neg_hi:[0,1]
    v_pk_add_f32 v[88:89], v[56:57], v[32:33] neg_lo:[0,1] neg_hi:[0,1]
    v_pk_add_f32 v[90:91], v[58:59], v[32:33] neg_lo:[0,1] neg_hi:[0,1]
    v_cvt_pk_bf16_f32 v136, v84, v85
    v_cvt_pk_bf16_f32 v137, v86, v87
    v_cvt_pk_bf16_f32 v138, v88, v89
    v_cvt_pk_bf16_f32 v139, v90, v91
    v_lshlrev_b32 v84, 16, v136
    v_and_b32 v85, s34, v136
    v_lshlrev_b32 v86, 16, v137
    v_and_b32 v87, s34, v137
    v_lshlrev_b32 v88, 16, v138
    v_and_b32 v89, s34, v138
    v_lshlrev_b32 v90, 16, v139
    v_and_b32 v91, s34, v139
    v_pk_mul_f32 v[84:85], v[84:85], v[34:35]
    v_pk_mul_f32 v[86:87], v[86:87], v[34:35]
    v_pk_mul_f32 v[88:89], v[88:89], v[34:35]
    v_pk_mul_f32 v[90:91], v[90:91], v[34:35]
    v_cvt_pk_bf16_f32 v136, v84, v85
    v_cvt_pk_bf16_f32 v137, v86, v87
    v_cvt_pk_bf16_f32 v138, v88, v89
    v_cvt_pk_bf16_f32 v139, v90, v91
    v_and_b32 v84, 0xffff, v136
    v_and_b32 v85, s34, v136
    v_and_b32 v86, 0xffff, v137
    v_and_b32 v87, s34, v137
    v_and_b32 v88, 0xffff, v138
    v_and_b32 v89, s34, v138
    v_and_b32 v90, 0xffff, v139
    v_and_b32 v91, s34, v139
    v_pk_add_f32 v[92:93], v[60:61], v[32:33] neg_lo:[0,1] neg_hi:[0,1]
    v_pk_add_f32 v[94:95], v[62:63], v[32:33] neg_lo:[0,1] neg_hi:[0,1]
    v_pk_add_f32 v[96:97], v[64:65], v[32:33] neg_lo:[0,1] neg_hi:[0,1]
    v_pk_add_f32 v[98:99], v[66:67], v[32:33] neg_lo:[0,1] neg_hi:[0,1]
    v_cvt_pk_bf16_f32 v136, v92, v93
    v_cvt_pk_bf16_f32 v137, v94, v95
    v_cvt_pk_bf16_f32 v138, v96, v97
    v_cvt_pk_bf16_f32 v139, v98, v99
    v_lshlrev_b32 v92, 16, v136
    v_and_b32 v93, s34, v136
    v_lshlrev_b32 v94, 16, v137
    v_and_b32 v95, s34, v137
    v_lshlrev_b32 v96, 16, v138
    v_and_b32 v97, s34, v138
    v_lshlrev_b32 v98, 16, v139
    v_and_b32 v99, s34, v139
    v_pk_mul_f32 v[92:93], v[92:93], v[34:35]
    v_pk_mul_f32 v[94:95], v[94:95], v[34:35]
    v_pk_mul_f32 v[96:97], v[96:97], v[34:35]
    v_pk_mul_f32 v[98:99], v[98:99], v[34:35]
    v_cvt_pk_bf16_f32 v136, v92, v93
    v_cvt_pk_bf16_f32 v137, v94, v95
    v_cvt_pk_bf16_f32 v138, v96, v97
    v_cvt_pk_bf16_f32 v139, v98, v99
    v_and_b32 v92, 0xffff, v136
    v_and_b32 v93, s34, v136
    v_and_b32 v94, 0xffff, v137
    v_and_b32 v95, s34, v137
    v_and_b32 v96, 0xffff, v138
    v_and_b32 v97, s34, v138
    v_and_b32 v98, 0xffff, v139
    v_and_b32 v99, s34, v139
    s_mov_b32 s48, 0
H_zs:
    ds_read_b32 v6, v14 offset:68
    s_add_u32 s48, s48, 1
    s_waitcnt lgkmcnt(0)
    v_cmp_gt_u32 vcc, 4, v6
    s_cbranch_vccz H_zs_d
    s_cmp_ge_u32 s48, 2000000
    s_cbranch_scc1 H_zs_d
    s_branch H_zs
H_zs_d:
    s_setprio 2
    s_add_u32 m0, s64, 0
    s_nop 0
    buffer_load_dwordx4 v246, s[44:47], 0 offen sc1 lds
    s_add_u32 m0, s64, 1024
    s_nop 0
    buffer_load_dwordx4 v246, s[44:47], s51 offen sc1 lds
    s_add_u32 m0, s64, 2048
    s_nop 0
    buffer_load_dwordx4 v246, s[44:47], s70 offen sc1 lds
    s_add_u32 m0, s64, 3072
    s_nop 0
    buffer_load_dwordx4 v246, s[44:47], s71 offen sc1 lds
    s_mov_b64 exec, 1
    ds_add_u32 v14, v15 offset:16
    s_mov_b64 exec, -1
    s_waitcnt vmcnt(4)
    ds_write_b128 v244, v[100:103] offset:33792
    s_mov_b64 exec, 1
    ds_add_u32 v14, v15 offset:28
    s_mov_b64 exec, -1
    s_mov_b32 s50, 0
    s_cmp_lg_u32 s39, 0
    s_cbranch_scc1 H_zslow
H_zw:
    s_add_u32 s50, s50, 1
    s_waitcnt vmcnt(0)
    ds_read_b128 v[116:119], v175 offset:0
    ds_read_b128 v[120:123], v175 offset:1024
    ds_read_b128 v[124:127], v175 offset:2048
    ds_read_b128 v[128:131], v175 offset:3072
    s_waitcnt lgkmcnt(0)
    v_max3_u32 v132, v116, v118, v120
    v_max3_u32 v133, v122, v124, v126
    v_max3_u32 v132, v132, v128, v130
    v_max_u32 v132, v132, v133
    v_cmp_le_u32 vcc, s34, v132
    s_cbranch_vccnz H_zretry
H_zdone:
    s_mov_b64 exec, 1
    ds_add_u32 v14, v15 offset:44
    s_mov_b64 exec, -1
    s_mov_b32 s48, 0
H_zd:
    ds_read_b32 v6, v14 offset:44
    s_add_u32 s48, s48, 1
    s_waitcnt lgkmcnt(0)
    v_cmp_gt_u32 vcc, 4, v6
    s_cbranch_vccz H_zd_d
    s_cmp_ge_u32 s48, 2000000
    s_cbranch_scc1 H_zd_d
    s_branch H_zd
H_zd_d:
    ds_read_b64_tr_b16 v[100:101], v174 offset:0
    ds_read_b64_tr_b16 v[102:103], v174 offset:512
    ds_read_b64_tr_b16 v[104:105], v174 offset:4096
    ds_read_b64_tr_b16 v[106:107], v174 offset:4608
    ds_read_b64_tr_b16 v[108:109], v174 offset:8192
    ds_read_b64_tr_b16 v[110:111], v174 offset:8704
    ds_read_b64_tr_b16 v[112:113], v174 offset:12288
    ds_read_b64_tr_b16 v[114:115], v174 offset:12800
    s_waitcnt lgkmcnt(6)
    v_dot2_f32_bf16 v132, v100, v68, 0
    v_dot2_f32_bf16 v133, v100, v69, 0
    v_dot2_f32_bf16 v134, v101, v70, 0
    v_dot2_f32_bf16 v135, v101, v71, 0
    v_dot2_f32_bf16 v136, v102, v72, 0
    v_dot2_f32_bf16 v137, v102, v73, 0
    v_dot2_f32_bf16 v138, v103, v74, 0
    v_dot2_f32_bf16 v139, v103, v75, 0
    v_cvt_pk_bf16_f32 v116, v132, v133
    v_cvt_pk_bf16_f32 v117, v134, v135
    v_cvt_pk_bf16_f32 v118, v136, v137
    v_cvt_pk_bf16_f32 v119, v138, v139
    v_dot2_f32_bf16 v132, v116, s41, v36
    v_dot2_f32_bf16 v133, v116, s42, v37
    v_dot2_f32_bf16 v134, v117, s41, v38
    v_dot2_f32_bf16 v135, v117, s42, v39
    v_dot2_f32_bf16 v136, v118, s41, v40
    v_dot2_f32_bf16 v137, v118, s42, v41
    v_dot2_f32_bf16 v138, v119, s41, v42
    v_dot2_f32_bf16 v139, v119, s42, v43
    v_cvt_pk_bf16_f32 v116, v132, v133
    v_cvt_pk_bf16_f32 v117, v134, v135
    v_cvt_pk_bf16_f32 v118, v136, v137
    v_cvt_pk_bf16_f32 v119, v138, v139
    s_waitcnt lgkmcnt(4)
    v_dot2_f32_bf16 v132, v104, v76, 0
    v_dot2_f32_bf16 v133, v104, v77, 0
    v_dot2_f32_bf16 v134, v105, v78, 0
    v_dot2_f32_bf16 v135, v105, v79, 0
    v_dot2_f32_bf16 v136, v106, v80, 0
    v_dot2_f32_bf16 v137, v106, v81, 0
    v_dot2_f32_bf16 v138, v107, v82, 0
    v_dot2_f32_bf16 v139, v107, v83, 0
    v_mfma_f32_16x16x32_bf16 v[140:143], v[158:161], v[116:119], 0
    v_cvt_pk_bf16_f32 v120, v132, v133
    v_cvt_pk_bf16_f32 v121, v134, v135
    v_cvt_pk_bf16_f32 v122, v136, v137
    v_cvt_pk_bf16_f32 v123, v138, v139
    v_dot2_f32_bf16 v132, v120, s41, v44
    v_dot2_f32_bf16 v133, v120, s42, v45
    v_dot2_f32_bf16 v134, v121, s41, v46
    v_dot2_f32_bf16 v135, v121, s42, v47
    v_dot2_f32_bf16 v136, v122, s41, v48
    v_dot2_f32_bf16 v137, v122, s42, v49
    v_dot2_f32_bf16 v138, v123, s41, v50
    v_dot2_f32_bf16 v139, v123, s42, v51
    v_mfma_f32_16x16x32_bf16 v[144:147], v[116:119], v[116:119], 0
    v_cvt_pk_bf16_f32 v120, v132, v133
    v_cvt_pk_bf16_f32 v121, v134, v135
    v_cvt_pk_bf16_f32 v122, v136, v137
    v_cvt_pk_bf16_f32 v123, v138, v139
    s_waitcnt lgkmcnt(2)
    v_dot2_f32_bf16 v132, v108, v84, 0
    v_dot2_f32_bf16 v133, v108, v85, 0
    v_dot2_f32_bf16 v134, v109, v86, 0
    v_dot2_f32_bf16 v135, v109, v87, 0
    v_dot2_f32_bf16 v136, v110, v88, 0
    v_dot2_f32_bf16 v137, v110, v89, 0
    v_dot2_f32_bf16 v138, v111, v90, 0
    v_dot2_f32_bf16 v139, v111, v91, 0
    v_mfma_f32_16x16x32_bf16 v[140:143], v[162:165], v[120:123], v[140:143]
    v_cvt_pk_bf16_f32 v124, v132, v133
    v_cvt_pk_bf16_f32 v125, v134, v135
    v_cvt_pk_bf16_f32 v126, v136, v137
    v_cvt_pk_bf16_f32 v127, v138, v139
    v_dot2_f32_bf16 v132, v124, s41, v52
    v_dot2_f32_bf16 v133, v124, s42, v53
    v_dot2_f32_bf16 v134, v125, s41, v54
    v_dot2_f32_bf16 v135, v125, s42, v55
    v_dot2_f32_bf16 v136, v126, s41, v56
    v_dot2_f32_bf16 v137, v126, s42, v57
    v_dot2_f32_bf16 v138, v127, s41, v58
    v_dot2_f32_bf16 v139, v127, s42, v59
    v_mfma_f32_16x16x32_bf16 v[144:147], v[120:123], v[120:123], v[144:147]
    v_cvt_pk_bf16_f32 v124, v132, v133
    v_cvt_pk_bf16_f32 v125, v134, v135
    v_cvt_pk_bf16_f32 v126, v136, v137
    v_cvt_pk_bf16_f32 v127, v138, v139
    s_waitcnt lgkmcnt(0)
    v_dot2_f32_bf16 v132, v112, v92, 0
    v_dot2_f32_bf16 v133, v112, v93, 0
    v_dot2_f32_bf16 v134, v113, v94, 0
    v_dot2_f32_bf16 v135, v113, v95, 0
    v_dot2_f32_bf16 v136, v114, v96, 0
    v_dot2_f32_bf16 v137, v114, v97, 0
    v_dot2_f32_bf16 v138, v115, v98, 0
    v_dot2_f32_bf16 v139, v115, v99, 0
    v_mfma_f32_16x16x32_bf16 v[140:143], v[166:169], v[124:127], v[140:143]
    v_cvt_pk_bf16_f32 v128, v132, v133
    v_cvt_pk_bf16_f32 v129, v134, v135
    v_cvt_pk_bf16_f32 v130, v136, v137
    v_cvt_pk_bf16_f32 v131, v138, v139
    v_dot2_f32_bf16 v132, v128, s41, v60
    v_dot2_f32_bf16 v133, v128, s42, v61
    v_dot2_f32_bf16 v134, v129, s41, v62
    v_dot2_f32_bf16 v135, v129, s42, v63
    v_dot2_f32_bf16 v136, v130, s41, v64
    v_dot2_f32_bf16 v137, v130, s42, v65
    v_dot2_f32_bf16 v138, v131, s41, v66
    v_dot2_f32_bf16 v139, v131, s42, v67
    v_mfma_f32_16x16x32_bf16 v[144:147], v[124:127], v[124:127], v[144:147]
    v_cvt_pk_bf16_f32 v128, v132, v133
    v_cvt_pk_bf16_f32 v129, v134, v135
    v_cvt_pk_bf16_f32 v130, v136, v137
    v_cvt_pk_bf16_f32 v131, v138, v139
    s_nop 1
    v_mfma_f32_16x16x32_bf16 v[144:147], v[128:131], v[128:131], v[144:147]
    v_mfma_f32_16x16x32_bf16 v[140:143], v[170:173], v[128:131], v[140:143]
    ds_write_b128 v251, v[116:119]
    ds_write_b128 v252, v[120:123]
    ds_write_b128 v253, v[124:127]
    ds_write_b128 v254, v[128:131]
    s_nop 2
    v_cndmask_b32 v144, v144, v145, s[56:57]
    v_cndmask_b32 v144, v144, v146, s[58:59]
    v_cndmask_b32 v141, v144, v147, s[60:61]
    v_mov_b32 v143, s38
    s_mov_b64 exec, s[66:67]
    global_store_dwordx4 v176, v[140:143], s[30:31] sc1
    s_mov_b64 exec, -1
    ds_write_b128 v245, v[208:211] offset:32768
    ds_write_b128 v245, v[212:215] offset:33792
    ds_write_b128 v245, v[216:219] offset:34816
    ds_write_b128 v245, v[220:223] offset:35840
    ds_write_b128 v245, v[224:227] offset:36864
    ds_write_b128 v245, v[228:231] offset:37888
    ds_write_b128 v245, v[232:235] offset:38912
    ds_write_b128 v245, v[236:239] offset:39936
    ds_write_b128 v245, v[16:19] offset:0
    ds_write_b128 v245, v[20:23] offset:1024
    ds_write_b128 v245, v[24:27] offset:2048
    ds_write_b128 v245, v[28:31] offset:3072
    ds_write_b128 v245, v[184:187] offset:4096
    ds_write_b128 v245, v[188:191] offset:5120
    ds_write_b128 v245, v[192:195] offset:6144
    ds_write_b128 v245, v[196:199] offset:7168
    s_mov_b64 exec, 1
    ds_add_u32 v14, v15 offset:24
    s_mov_b64 exec, -1
    v_lshlrev_b32 v68, 16, v116
    v_and_b32 v69, s34, v116
    v_lshlrev_b32 v70, 16, v117
    v_and_b32 v71, s34, v117
    v_lshlrev_b32 v72, 16, v118
    v_and_b32 v73, s34, v118
    v_lshlrev_b32 v74, 16, v119
    v_and_b32 v75, s34, v119
    v_lshlrev_b32 v76, 16, v120
    v_and_b32 v77, s34, v120
    v_lshlrev_b32 v78, 16, v121
    v_and_b32 v79, s34, v121
    v_lshlrev_b32 v80, 16, v122
    v_and_b32 v81, s34, v122
    v_lshlrev_b32 v82, 16, v123
    v_and_b32 v83, s34, v123
    v_lshlrev_b32 v84, 16, v124
    v_and_b32 v85, s34, v124
    v_lshlrev_b32 v86, 16, v125
    v_and_b32 v87, s34, v125
    v_lshlrev_b32 v88, 16, v126
    v_and_b32 v89, s34, v126
    v_lshlrev_b32 v90, 16, v127
    v_and_b32 v91, s34, v127
    v_lshlrev_b32 v92, 16, v128
    v_and_b32 v93, s34, v128
    v_lshlrev_b32 v94, 16, v129
    v_and_b32 v95, s34, v129
    v_lshlrev_b32 v96, 16, v130
    v_and_b32 v97, s34, v130
    v_lshlrev_b32 v98, 16, v131
    v_and_b32 v99, s34, v131
    v_mov_b32 v39, s38
    v_bfe_u32 v3, v1, 1, 4
    v_and_b32 v2, 1, v1
    s_lshl_b32 s48, s32, 12
    v_lshl_add_u32 v2, v2, 3, s48
    s_sleep 4
    global_load_dwordx4 v[148:151], v177, s[30:31] sc1
    global_load_dwordx4 v[152:155], v177, s[30:31] offset:1024 sc1
    s_mov_b32 s48, 0
H_p2_loop:
    s_waitcnt vmcnt(0)
    v_cmp_ne_u32 s[52:53], s38, v151
    v_cmp_ne_u32 s[54:55], s38, v155
    s_or_b64 vcc, s[52:53], s[54:55]
    s_cbranch_scc0 H_p2_done
    s_add_u32 s48, s48, 1
    s_cmp_ge_u32 s48, 100000
    s_cbranch_scc1 H_p2_done
    s_sleep 1
    s_mov_b64 exec, s[52:53]
    global_load_dwordx4 v[148:151], v177, s[30:31] sc1
    s_mov_b64 exec, s[54:55]
    global_load_dwordx4 v[152:155], v177, s[30:31] offset:1024 sc1
    s_mov_b64 exec, -1
    s_branch H_p2_loop
H_p2_done:
    s_mov_b64 exec, 1
    ds_add_u32 v14, v15 offset:64
    s_mov_b64 exec, -1
    v_add_f32 v148, v148, v152
    v_add_f32 v149, v149, v153
    v_add_f32 v150, v150, v154
    v_mov_b32 v152, v148
    v_mov_b32 v153, v149
    v_mov_b32 v154, v150
    v_permlane32_swap_b32 v148, v152
    v_permlane32_swap_b32 v149, v153
    v_permlane32_swap_b32 v150, v154
    v_add_f32 v148, v148, v152
    v_add_f32 v149, v149, v153
    v_add_f32 v150, v150, v154
    v_mov_b32 v152, v148
    v_mov_b32 v153, v149
    v_mov_b32 v154, v150
    v_permlane16_swap_b32 v148, v152
    v_permlane16_swap_b32 v149, v153
    v_permlane16_swap_b32 v150, v154
    v_add_f32 v148, v148, v152
    v_add_f32 v149, v149, v153
    v_add_f32 v150, v150, v154
    v_mul_f32 v32, 0x3a800000, v148
    v_mul_f32 v34, 0x3a800000, v149
    v_fma_f32 v34, -v32, v32, v34
    v_max_f32 v34, 0, v34
    v_cvt_pk_bf16_f32 v134, v32, v34
    v_and_b32 v34, s34, v134
    v_add_f32 v34, 0x3727c5ac, v34
    v_cvt_pk_bf16_f32 v34, v34, v34
    v_and_b32 v34, s34, v34
    v_sqrt_f32 v34, v34
    v_lshlrev_b32 v32, 16, v134
    v_cvt_pk_bf16_f32 v34, v34, v34
    v_and_b32 v34, s34, v34
    v_rcp_f32 v34, v34
    v_fma_f32 v135, -v179, v32, v150
    v_mul_f32 v135, v135, v34
    v_ashrrev_i32 v134, 31, v135
    v_or_b32 v134, 0x80000000, v134
    v_xor_b32 v135, v135, v134
    v_and_or_b32 v135, v135, s65, v178
    s_mov_b64 exec, 0xffff
    ds_max_u32 v14, v135 offset:36
    s_mov_b64 exec, 1
    ds_add_u32 v14, v15 offset:32
    s_mov_b64 exec, -1
    v_max_u32_dpp v38, v135, v135 row_ror:8 row_mask:0xf bank_mask:0xf
    s_nop 1
    v_max_u32_dpp v38, v38, v38 row_ror:4 row_mask:0xf bank_mask:0xf
    s_nop 1
    v_max_u32_dpp v38, v38, v38 row_ror:2 row_mask:0xf bank_mask:0xf
    s_nop 1
    v_max_u32_dpp v38, v38, v38 row_ror:1 row_mask:0xf bank_mask:0xf
    v_cmp_eq_u32 vcc, v38, v135
    v_readfirstlane_b32 s52, v38
    s_ff1_i32_b32 s53, vcc_lo
    v_xor_b32 v3, s53, v3
    s_lshl_b32 s56, s53, 8
    v_lshl_add_u32 v2, v3, 4, v2
    v_add_u32 v2, s56, v2
    ds_read_b64 v[40:41], v2
    v_readlane_b32 s54, v32, s53
    v_readlane_b32 s58, v34, s53
    v_readlane_b32 s55, v32, s53
    v_readlane_b32 s59, v34, s53
    v_mov_b32 v33, v32
    v_mov_b32 v35, v34
    s_waitcnt lgkmcnt(0)
    v_lshlrev_b32 v148, 16, v40
    v_and_b32 v149, s34, v40
    v_lshlrev_b32 v150, 16, v41
    v_and_b32 v151, s34, v41
    v_pk_add_f32 v[148:149], v[148:149], s[54:55] neg_lo:[0,1] neg_hi:[0,1]
    v_pk_add_f32 v[150:151], v[150:151], s[54:55] neg_lo:[0,1] neg_hi:[0,1]
    v_cvt_pk_bf16_f32 v136, v148, v149
    v_cvt_pk_bf16_f32 v137, v150, v151
    v_lshlrev_b32 v148, 16, v136
    v_and_b32 v149, s34, v136
    v_lshlrev_b32 v150, 16, v137
    v_and_b32 v151, s34, v137
    v_pk_mul_f32 v[148:149], v[148:149], s[58:59]
    v_pk_mul_f32 v[150:151], v[150:151], s[58:59]
    v_cvt_pk_bf16_f32 v36, v148, v149
    v_cvt_pk_bf16_f32 v37, v150, v151
    s_mov_b32 s48, 0
H_ha:
    ds_read_b64 v[6:7], v14 offset:32
    s_add_u32 s48, s48, 1
    s_waitcnt lgkmcnt(0)
    v_cmp_gt_u32 vcc, 4, v6
    s_cbranch_vccz H_ha_d
    s_cmp_ge_u32 s48, 2000000
    s_cbranch_scc1 H_ha_d
    s_branch H_ha
H_ha_d:
    v_readfirstlane_b32 s48, v7
    s_cmp_lg_u32 s48, s52
    s_cbranch_scc1 H_nopub
    s_mov_b32 exec_hi, 0
    s_cmp_lg_u32 s39, 0
    s_cbranch_scc1 H_pubg
    global_store_dwordx4 v180, v[36:39], s[30:31]
H_pubd:
    ds_write2_b64 v181, v[40:41], v[36:37] offset0:0 offset1:32
    s_mov_b64 exec, 1
    ds_add_u32 v14, v15 offset:40
    s_mov_b64 exec, -1
H_nopub:
    v_pk_add_f32 v[148:149], v[68:69], v[32:33] neg_lo:[0,1] neg_hi:[0,1]
    v_pk_add_f32 v[150:151], v[70:71], v[32:33] neg_lo:[0,1] neg_hi:[0,1]
    v_pk_add_f32 v[152:153], v[72:73], v[32:33] neg_lo:[0,1] neg_hi:[0,1]
    v_pk_add_f32 v[154:155], v[74:75], v[32:33] neg_lo:[0,1] neg_hi:[0,1]
    v_cvt_pk_bf16_f32 v132, v148, v149
    v_cvt_pk_bf16_f32 v133, v150, v151
    v_cvt_pk_bf16_f32 v134, v152, v153
    v_cvt_pk_bf16_f32 v135, v154, v155
    v_lshlrev_b32 v148, 16, v132
    v_and_b32 v149, s34, v132
    v_lshlrev_b32 v150, 16, v133
    v_and_b32 v151, s34, v133
    v_lshlrev_b32 v152, 16, v134
    v_and_b32 v153, s34, v134
    v_lshlrev_b32 v154, 16, v135
    v_and_b32 v155, s34, v135
    v_pk_mul_f32 v[148:149], v[148:149], v[34:35]
    v_pk_mul_f32 v[150:151], v[150:151], v[34:35]
    v_pk_mul_f32 v[152:153], v[152:153], v[34:35]
    v_pk_mul_f32 v[154:155], v[154:155], v[34:35]
    v_cvt_pk_bf16_f32 v132, v148, v149
    v_cvt_pk_bf16_f32 v133, v150, v151
    v_cvt_pk_bf16_f32 v134, v152, v153
    v_cvt_pk_bf16_f32 v135, v154, v155
    v_lshlrev_b32 v148, 16, v132
    v_and_b32 v149, s34, v132
    v_lshlrev_b32 v150, 16, v133
    v_and_b32 v151, s34, v133
    v_lshlrev_b32 v152, 16, v134
    v_and_b32 v153, s34, v134
    v_lshlrev_b32 v154, 16, v135
    v_and_b32 v155, s34, v135
    v_pk_add_f32 v[148:149], v[148:149], v[68:69]
    v_pk_add_f32 v[150:151], v[150:151], v[70:71]
    v_pk_add_f32 v[152:153], v[152:153], v[72:73]
    v_pk_add_f32 v[154:155], v[154:155], v[74:75]
    v_cvt_pk_bf16_f32 v116, v148, v149
    v_cvt_pk_bf16_f32 v117, v150, v151
    v_cvt_pk_bf16_f32 v118, v152, v153
    v_cvt_pk_bf16_f32 v119, v154, v155
    ds_write_b128 v251, v[116:119]
    v_pk_add_f32 v[148:149], v[76:77], v[32:33] neg_lo:[0,1] neg_hi:[0,1]
    v_pk_add_f32 v[150:151], v[78:79], v[32:33] neg_lo:[0,1] neg_hi:[0,1]
    v_pk_add_f32 v[152:153], v[80:81], v[32:33] neg_lo:[0,1] neg_hi:[0,1]
    v_pk_add_f32 v[154:155], v[82:83], v[32:33] neg_lo:[0,1] neg_hi:[0,1]
    v_cvt_pk_bf16_f32 v132, v148, v149
    v_cvt_pk_bf16_f32 v133, v150, v151
    v_cvt_pk_bf16_f32 v134, v152, v153
    v_cvt_pk_bf16_f32 v135, v154, v155
    v_lshlrev_b32 v148, 16, v132
    v_and_b32 v149, s34, v132
    v_lshlrev_b32 v150, 16, v133
    v_and_b32 v151, s34, v133
    v_lshlrev_b32 v152, 16, v134
    v_and_b32 v153, s34, v134
    v_lshlrev_b32 v154, 16, v135
    v_and_b32 v155, s34, v135
    v_pk_mul_f32 v[148:149], v[148:149], v[34:35]
    v_pk_mul_f32 v[150:151], v[150:151], v[34:35]
    v_pk_mul_f32 v[152:153], v[152:153], v[34:35]
    v_pk_mul_f32 v[154:155], v[154:155], v[34:35]
    v_cvt_pk_bf16_f32 v132, v148, v149
    v_cvt_pk_bf16_f32 v133, v150, v151
    v_cvt_pk_bf16_f32 v134, v152, v153
    v_cvt_pk_bf16_f32 v135, v154, v155
    v_lshlrev_b32 v148, 16, v132
    v_and_b32 v149, s34, v132
    v_lshlrev_b32 v150, 16, v133
    v_and_b32 v151, s34, v133
    v_lshlrev_b32 v152, 16, v134
    v_and_b32 v153, s34, v134
    v_lshlrev_b32 v154, 16, v135
    v_and_b32 v155, s34, v135
    v_pk_add_f32 v[148:149], v[148:149], v[76:77]
    v_pk_add_f32 v[150:151], v[150:151], v[78:79]
    v_pk_add_f32 v[152:153], v[152:153], v[80:81]
    v_pk_add_f32 v[154:155], v[154:155], v[82:83]
    v_cvt_pk_bf16_f32 v120, v148, v149
    v_cvt_pk_bf16_f32 v121, v150, v151
    v_cvt_pk_bf16_f32 v122, v152, v153
    v_cvt_pk_bf16_f32 v123, v154, v155
    ds_write_b128 v252, v[120:123]
    v_pk_add_f32 v[148:149], v[84:85], v[32:33] neg_lo:[0,1] neg_hi:[0,1]
    v_pk_add_f32 v[150:151], v[86:87], v[32:33] neg_lo:[0,1] neg_hi:[0,1]
    v_pk_add_f32 v[152:153], v[88:89], v[32:33] neg_lo:[0,1] neg_hi:[0,1]
    v_pk_add_f32 v[154:155], v[90:91], v[32:33] neg_lo:[0,1] neg_hi:[0,1]
    v_cvt_pk_bf16_f32 v132, v148, v149
    v_cvt_pk_bf16_f32 v133, v150, v151
    v_cvt_pk_bf16_f32 v134, v152, v153
    v_cvt_pk_bf16_f32 v135, v154, v155
    v_lshlrev_b32 v148, 16, v132
    v_and_b32 v149, s34, v132
    v_lshlrev_b32 v150, 16, v133
    v_and_b32 v151, s34, v133
    v_lshlrev_b32 v152, 16, v134
    v_and_b32 v153, s34, v134
    v_lshlrev_b32 v154, 16, v135
    v_and_b32 v155, s34, v135
    v_pk_mul_f32 v[148:149], v[148:149], v[34:35]
    v_pk_mul_f32 v[150:151], v[150:151], v[34:35]
    v_pk_mul_f32 v[152:153], v[152:153], v[34:35]
    v_pk_mul_f32 v[154:155], v[154:155], v[34:35]
    v_cvt_pk_bf16_f32 v132, v148, v149
    v_cvt_pk_bf16_f32 v133, v150, v151
    v_cvt_pk_bf16_f32 v134, v152, v153
    v_cvt_pk_bf16_f32 v135, v154, v155
    v_lshlrev_b32 v148, 16, v132
    v_and_b32 v149, s34, v132
    v_lshlrev_b32 v150, 16, v133
    v_and_b32 v151, s34, v133
    v_lshlrev_b32 v152, 16, v134
    v_and_b32 v153, s34, v134
    v_lshlrev_b32 v154, 16, v135
    v_and_b32 v155, s34, v135
    v_pk_add_f32 v[148:149], v[148:149], v[84:85]
    v_pk_add_f32 v[150:151], v[150:151], v[86:87]
    v_pk_add_f32 v[152:153], v[152:153], v[88:89]
    v_pk_add_f32 v[154:155], v[154:155], v[90:91]
    v_cvt_pk_bf16_f32 v124, v148, v149
    v_cvt_pk_bf16_f32 v125, v150, v151
    v_cvt_pk_bf16_f32 v126, v152, v153
    v_cvt_pk_bf16_f32 v127, v154, v155
    ds_write_b128 v253, v[124:127]
    v_pk_add_f32 v[148:149], v[92:93], v[32:33] neg_lo:[0,1] neg_hi:[0,1]
    v_pk_add_f32 v[150:151], v[94:95], v[32:33] neg_lo:[0,1] neg_hi:[0,1]
    v_pk_add_f32 v[152:153], v[96:97], v[32:33] neg_lo:[0,1] neg_hi:[0,1]
    v_pk_add_f32 v[154:155], v[98:99], v[32:33] neg_lo:[0,1] neg_hi:[0,1]
    v_cvt_pk_bf16_f32 v132, v148, v149
    v_cvt_pk_bf16_f32 v133, v150, v151
    v_cvt_pk_bf16_f32 v134, v152, v153
    v_cvt_pk_bf16_f32 v135, v154, v155
    v_lshlrev_b32 v148, 16, v132
    v_and_b32 v149, s34, v132
    v_lshlrev_b32 v150, 16, v133
    v_and_b32 v151, s34, v133
    v_lshlrev_b32 v152, 16, v134
    v_and_b32 v153, s34, v134
    v_lshlrev_b32 v154, 16, v135
    v_and_b32 v155, s34, v135
    v_pk_mul_f32 v[148:149], v[148:149], v[34:35]
    v_pk_mul_f32 v[150:151], v[150:151], v[34:35]
    v_pk_mul_f32 v[152:153], v[152:153], v[34:35]
    v_pk_mul_f32 v[154:155], v[154:155], v[34:35]
    v_cvt_pk_bf16_f32 v132, v148, v149
    v_cvt_pk_bf16_f32 v133, v150, v151
    v_cvt_pk_bf16_f32 v134, v152, v153
    v_cvt_pk_bf16_f32 v135, v154, v155
    v_lshlrev_b32 v148, 16, v132
    v_and_b32 v149, s34, v132
    v_lshlrev_b32 v150, 16, v133
    v_and_b32 v151, s34, v133
    v_lshlrev_b32 v152, 16, v134
    v_and_b32 v153, s34, v134
    v_lshlrev_b32 v154, 16, v135
    v_and_b32 v155, s34, v135
    v_pk_add_f32 v[148:149], v[148:149], v[92:93]
    v_pk_add_f32 v[150:151], v[150:151], v[94:95]
    v_pk_add_f32 v[152:153], v[152:153], v[96:97]
    v_pk_add_f32 v[154:155], v[154:155], v[98:99]
    v_cvt_pk_bf16_f32 v128, v148, v149
    v_cvt_pk_bf16_f32 v129, v150, v151
    v_cvt_pk_bf16_f32 v130, v152, v153
    v_cvt_pk_bf16_f32 v131, v154, v155
    ds_write_b128 v254, v[128:131]
    ds_read_b128 v[184:187], v247 offset:0
    ds_read_b128 v[188:191], v248 offset:1024
    ds_read_b128 v[192:195], v249 offset:2048
    ds_read_b128 v[196:199], v250 offset:3072
    s_mov_b32 s48, 0
H_rc:
    ds_read_b64 v[6:7], v14 offset:48
    s_add_u32 s48, s48, 1
    s_waitcnt lgkmcnt(0)
    v_cmp_gt_u32 vcc, 4, v6
    s_cbranch_vccz H_rc_d
    s_cmp_ge_u32 s48, 2000000
    s_cbranch_scc1 H_rc_d
    s_sleep 1
    s_branch H_rc
H_rc_d:
    v_readfirstlane_b32 s52, v7
    s_andn2_b32 s53, 0x7ff, s52
    s_sub_u32 s58, s53, s17
    s_andn2_b32 s58, s58, 6
    s_lshl_b32 s56, s53, 3
    s_and_b32 s56, s56, 48
    s_lshl_b64 s[56:57], 0xffff, s56
    s_not_b64 s[56:57], s[56:57]
    s_andn2_b32 s54, s53, 0x6f
    s_cmp_eq_u32 s54, s16
    s_cbranch_scc1 H_own
    s_mov_b32 s48, 0
H_owa:
    ds_read_b32 v6, v14 offset:76
    s_add_u32 s48, s48, 1
    s_waitcnt lgkmcnt(0)
    v_cmp_gt_u32 vcc, 8, v6
    s_cbranch_vccz H_owa_d
    s_cmp_ge_u32 s48, 2000000
    s_cbranch_scc1 H_owa_d
    s_branch H_owa
H_owa_d:
    s_cmp_eq_u32 s58, 0
    s_cselect_b64 exec, s[56:57], -1
    global_store_dwordx4 v204, v[184:187], s[26:27] offset:0 nt
    s_cmp_eq_u32 s58, 1
    s_cselect_b64 exec, s[56:57], -1
    global_store_dwordx4 v204, v[188:191], s[26:27] offset:2048 nt
    s_cmp_eq_u32 s58, 8
    s_cselect_b64 exec, s[56:57], -1
    global_store_dwordx4 v205, v[192:195], s[26:27] offset:0 nt
    s_cmp_eq_u32 s58, 9
    s_cselect_b64 exec, s[56:57], -1
    global_store_dwordx4 v205, v[196:199], s[26:27] offset:2048 nt
    s_mov_b64 exec, -1
    s_branch B_fin
H_own:
    s_mov_b32 s48, 0
H_mid:
    ds_read_b32 v6, v14 offset:76
    s_add_u32 s48, s48, 1
    s_waitcnt lgkmcnt(0)
    v_cmp_gt_u32 vcc, 8, v6
    s_cbranch_vccz H_mid_d
    s_cmp_ge_u32 s48, 2000000
    s_cbranch_scc1 H_mid_d
    s_branch H_mid
H_mid_d:
    s_cmp_eq_u32 s58, 0
    s_cselect_b64 exec, s[56:57], -1
    global_store_dwordx4 v204, v[184:187], s[26:27] offset:0 nt
    s_cmp_eq_u32 s58, 1
    s_cselect_b64 exec, s[56:57], -1
    global_store_dwordx4 v204, v[188:191], s[26:27] offset:2048 nt
    s_cmp_eq_u32 s58, 8
    s_cselect_b64 exec, s[56:57], -1
    global_store_dwordx4 v205, v[192:195], s[26:27] offset:0 nt
    s_cmp_eq_u32 s58, 9
    s_cselect_b64 exec, s[56:57], -1
    global_store_dwordx4 v205, v[196:199], s[26:27] offset:2048 nt
    s_mov_b64 exec, -1
    v_lshrrev_b32 v2, 5, v1
    v_lshl_add_u32 v2, v2, 4, v8
    s_lshl_b32 s48, s32, 5
    v_add_u32 v2, s48, v2
    v_lshlrev_b32 v2, 1, v2
    v_add_u32 v3, 160768, v2
    ds_read_u16 v36, v3
    ds_read_u16 v37, v3 offset:256
    s_lshl_b32 s48, s53, 11
    s_lshl_b32 s49, s33, 8
    s_add_u32 s48, s48, s49
    v_add_u32 v39, s48, v2
    v_mov_b32 v38, s52
    v_ashrrev_i32 v7, 31, v38
    v_not_b32 v7, v7
    v_or_b32 v7, 0x80000000, v7
    v_xor_b32 v38, v38, v7
    v_cvt_pk_bf16_f32 v38, v38, v38
    v_and_b32 v38, s34, v38
    v_mul_f32 v38, 0xbfb8aa3b, v38
    v_exp_f32 v38, v38
    s_nop 0
    v_add_f32 v38, 1.0, v38
    v_rcp_f32 v38, v38
    s_nop 0
    v_cvt_pk_bf16_f32 v38, v38, v38
    v_and_b32 v38, s34, v38
    s_lshl_b32 s49, s32, 8
    s_add_u32 s48, s69, s49
    s_add_u32 s48, s48, 1724416
    v_lshlrev_b32 v40, 10, v9
    v_lshl_add_u32 v40, v8, 4, v40
    v_add_u32 v40, s48, v40
    v_add_u32 v41, 8192, v40
    v_add_u32 v42, 16384, v40
    v_add_u32 v43, 24576, v40
    s_waitcnt lgkmcnt(0)
    v_lshlrev_b32 v36, 16, v36
    v_lshlrev_b32 v37, 16, v37
    s_mov_b32 s48, 0
H_pt:
    ds_read_b32 v6, v14 offset:60
    s_add_u32 s48, s48, 1
    s_waitcnt lgkmcnt(0)
    v_cmp_gt_u32 vcc, 4, v6
    s_cbranch_vccz H_pt_d
    s_cmp_ge_u32 s48, 2000000
    s_cbranch_scc1 H_pt_d
    s_branch H_pt
H_pt_d:
    s_sleep 1
    global_load_dwordx4 v[44:47], v40, s[30:31] offset:-4096 sc1
    global_load_dwordx4 v[48:51], v40, s[30:31] offset:0 sc1
    global_load_dwordx4 v[52:55], v41, s[30:31] offset:-4096 sc1
    global_load_dwordx4 v[56:59], v41, s[30:31] offset:0 sc1
    global_load_dwordx4 v[60:63], v42, s[30:31] offset:-4096 sc1
    global_load_dwordx4 v[64:67], v42, s[30:31] offset:0 sc1
    global_load_dwordx4 v[68:71], v43, s[30:31] offset:-4096 sc1
    s_mov_b32 s48, 0
H_pf_loop:
    s_waitcnt vmcnt(0)
    v_cmp_ne_u32 s[52:53], s38, v46
    v_cmp_ne_u32 s[54:55], s38, v50
    v_cmp_ne_u32 s[60:61], s38, v54
    v_cmp_ne_u32 s[62:63], s38, v58
    v_cmp_ne_u32 s[40:41], s38, v62
    v_cmp_ne_u32 s[44:45], s38, v66
    v_cmp_ne_u32 s[46:47], s38, v70
    s_or_b64 vcc, s[52:53], s[54:55]
    s_or_b64 vcc, vcc, s[60:61]
    s_or_b64 vcc, vcc, s[62:63]
    s_or_b64 vcc, vcc, s[40:41]
    s_or_b64 vcc, vcc, s[44:45]
    s_or_b64 vcc, vcc, s[46:47]
    s_cbranch_scc0 H_pf_done
    s_add_u32 s48, s48, 1
    s_cmp_ge_u32 s48, 100000
    s_cbranch_scc1 H_pf_done
    s_mov_b64 exec, s[52:53]
    global_load_dwordx4 v[44:47], v40, s[30:31] offset:-4096 sc1
    s_mov_b64 exec, s[54:55]
    global_load_dwordx4 v[48:51], v40, s[30:31] offset:0 sc1
    s_mov_b64 exec, s[60:61]
    global_load_dwordx4 v[52:55], v41, s[30:31] offset:-4096 sc1
    s_mov_b64 exec, s[62:63]
    global_load_dwordx4 v[56:59], v41, s[30:31] offset:0 sc1
    s_mov_b64 exec, s[40:41]
    global_load_dwordx4 v[60:63], v42, s[30:31] offset:-4096 sc1
    s_mov_b64 exec, s[44:45]
    global_load_dwordx4 v[64:67], v42, s[30:31] offset:0 sc1
    s_mov_b64 exec, s[46:47]
    global_load_dwordx4 v[68:71], v43, s[30:31] offset:-4096 sc1
    s_mov_b64 exec, -1
    s_branch H_pf_loop
H_pf_done:
    v_pk_add_f32 v[44:45], v[44:45], v[48:49]
    v_pk_add_f32 v[52:53], v[52:53], v[56:57]
    v_pk_add_f32 v[60:61], v[60:61], v[64:65]
    v_pk_add_f32 v[44:45], v[44:45], v[52:53]
    v_pk_add_f32 v[60:61], v[60:61], v[68:69]
    v_pk_add_f32 v[44:45], v[44:45], v[60:61]
    s_nop 1
    v_permlane32_swap_b32 v44, v45
    v_add_f32 v44, v44, v45
    v_mov_b32 v46, v44
    s_nop 1
    v_permlane16_swap_b32 v44, v46
    v_add_f32 v44, v44, v46
    v_cvt_pk_bf16_f32 v44, v44, v44
    v_and_b32 v44, s34, v44
    v_mul_f32 v44, v44, v38
    v_cvt_pk_bf16_f32 v44, v44, v44
    v_and_b32 v44, s34, v44
    v_add_f32 v44, v44, v37
    v_cvt_pk_bf16_f32 v44, v44, v44
    v_and_b32 v44, s34, v44
    v_add_f32 v44, v44, v36
    v_cvt_pk_bf16_f32 v44, v44, v44
    s_mov_b32 s48, 0xffff
    s_mov_b32 s49, 0xffff
    s_mov_b64 exec, s[48:49]
    global_store_short v39, v44, s[26:27]
    s_mov_b64 exec, -1
    s_branch B_fin
H_pubg:
    global_store_dwordx4 v180, v[36:39], s[30:31] sc1
    s_branch H_pubd
H_zslow:
    s_add_u32 s48, s69, 1753088
    v_lshl_add_u32 v2, v1, 3, s48
    s_mov_b32 s48, 0
H_zsl_loop:
    global_load_dwordx2 v[132:133], v2, s[30:31] sc1
    s_add_u32 s48, s48, 1
    s_waitcnt vmcnt(0)
    v_xor_b32 v134, s38, v132
    v_bitop3_b32 v134, v133, s38, v134 bitop3:0xbe
    v_cmp_ne_u32 vcc, 0, v134
    s_cbranch_vccz H_zsl_done
    s_cmp_ge_u32 s48, 100000
    s_cbranch_scc1 H_zsl_done
    s_sleep 4
    s_branch H_zsl_loop
H_zsl_done:
    s_branch H_zfb
H_zretry:
    s_cmp_ge_u32 s50, 100000
    s_cbranch_scc1 H_zdone
    s_cmp_ge_u32 s50, 64
    s_cbranch_scc1 H_zfb
    v_max_u32 v132, v116, v118
    s_add_u32 m0, s64, 0
    v_cmp_le_u32 vcc, s34, v132
    s_mov_b64 exec, vcc
    buffer_load_dwordx4 v246, s[44:47], 0 offen sc1 lds
    s_mov_b64 exec, -1
    v_max_u32 v132, v120, v122
    s_add_u32 m0, s64, 1024
    v_cmp_le_u32 vcc, s34, v132
    s_mov_b64 exec, vcc
    buffer_load_dwordx4 v246, s[44:47], s51 offen sc1 lds
    s_mov_b64 exec, -1
    v_max_u32 v132, v124, v126
    s_add_u32 m0, s64, 2048
    v_cmp_le_u32 vcc, s34, v132
    s_mov_b64 exec, vcc
    buffer_load_dwordx4 v246, s[44:47], s70 offen sc1 lds
    s_mov_b64 exec, -1
    v_max_u32 v132, v128, v130
    s_add_u32 m0, s64, 3072
    v_cmp_le_u32 vcc, s34, v132
    s_mov_b64 exec, vcc
    buffer_load_dwordx4 v246, s[44:47], s71 offen sc1 lds
    s_mov_b64 exec, -1
    s_branch H_zw
H_zfb:
    v_lshrrev_b32 v3, 3, v1
    s_lshl_b32 s48, s32, 7
    s_add_u32 s48, s48, s69
    s_add_u32 s48, s48, 1753088
    v_lshl_add_u32 v2, v3, 2, s48
    global_load_dword v132, v2, s[30:31] offset:0 sc1
    global_load_dword v133, v2, s[30:31] offset:32 sc1
    global_load_dword v134, v2, s[30:31] offset:64 sc1
    global_load_dword v135, v2, s[30:31] offset:96 sc1
    s_lshl_b32 s48, s35, 14
    s_add_u32 s48, s48, s69
    s_add_u32 s48, s48, 1048576
    s_add_u32 s52, s30, s48
    s_addc_u32 s53, s31, 0
    s_movk_i32 s54, 16384
    s_mov_b32 s55, 0x20000
    s_lshl_b32 s48, s32, 12
    v_lshl_add_u32 v2, v1, 4, s48
    s_waitcnt vmcnt(0) lgkmcnt(0)
    s_add_u32 m0, s64, 0
    v_cmp_eq_u32 vcc, s38, v132
    s_mov_b64 exec, vcc
    buffer_load_dwordx4 v2, s[52:55], 0 offen sc1 lds
    s_not_b64 exec, vcc
    buffer_load_dwordx4 v246, s[44:47], 0 offen sc1 lds
    s_mov_b64 exec, -1
    v_add_u32 v2, 1024, v2
    s_add_u32 m0, s64, 1024
    v_cmp_eq_u32 vcc, s38, v133
    s_mov_b64 exec, vcc
    buffer_load_dwordx4 v2, s[52:55], 0 offen sc1 lds
    s_not_b64 exec, vcc
    buffer_load_dwordx4 v246, s[44:47], s51 offen sc1 lds
    s_mov_b64 exec, -1
    v_add_u32 v2, 1024, v2
    s_add_u32 m0, s64, 2048
    v_cmp_eq_u32 vcc, s38, v134
    s_mov_b64 exec, vcc
    buffer_load_dwordx4 v2, s[52:55], 0 offen sc1 lds
    s_not_b64 exec, vcc
    buffer_load_dwordx4 v246, s[44:47], s70 offen sc1 lds
    s_mov_b64 exec, -1
    v_add_u32 v2, 1024, v2
    s_add_u32 m0, s64, 3072
    v_cmp_eq_u32 vcc, s38, v135
    s_mov_b64 exec, vcc
    buffer_load_dwordx4 v2, s[52:55], 0 offen sc1 lds
    s_not_b64 exec, vcc
    buffer_load_dwordx4 v246, s[44:47], s71 offen sc1 lds
    s_mov_b64 exec, -1
    v_add_u32 v2, 1024, v2
    s_branch H_zw
B_M:
    v_and_b32 v8, 15, v1
    v_lshrrev_b32 v9, 4, v1
    v_lshlrev_b32 v10, 4, v1
    v_mov_b32 v48, 0
    v_mov_b32 v49, 0
    v_mov_b32 v50, 0
    v_mov_b32 v51, 0
    v_lshl_add_u32 v19, v9, 2, v8
    s_waitcnt lgkmcnt(0)
    s_add_u32 s48, s30, 17760256
    s_addc_u32 s49, s31, 0
    s_load_dword s38, s[48:49], 0
    v_lshlrev_b32 v10, 4, v1
    s_mul_i32 s65, s36, 8448
    s_mul_i32 s66, s36, 9152
    s_add_u32 s66, s66, 33792
    v_and_b32 v13, 31, v1
    v_min_u32 v13, 29, v13
    v_lshlrev_b32 v13, 4, v13
    v_lshrrev_b32 v12, 5, v1
    v_mul_u32_u24 v12, 4576, v12
    v_add3_u32 v13, v13, v12, s66
    ds_write_b128 v13, v[48:51] offset:4096
    s_lshl_b32 s48, s37, 2
    s_add_u32 s48, s48, s36
    s_lshl_b32 s71, s48, 12
    s_lshl_b32 s50, s48, 1
    s_and_b32 s50, s50, 0xfffffffc
    v_and_b32 v13, 1, v9
    v_add_u32 v13, v13, v8
    v_lshlrev_b32 v13, 2, v13
    v_subrev_u32 v13, 64, v13
    v_and_b32 v12, 1, v9
    v_mul_u32_u24 v12, 4224, v12
    v_lshl_add_u32 v12, v8, 2, v12
    v_add_u32 v12, s65, v12
    s_movk_i32 s62, 4096
    s_mov_b32 s63, 0x20000
    s_lshl_b32 s69, s33, 21
    s_lshl_b32 s48, s35, 2
    s_add_u32 s48, s48, s36
    s_lshr_b32 s16, s35, 1
    s_lshl_b32 s16, s16, 7
    s_and_b32 s17, s35, 1
    s_lshl_b32 s17, s17, 4
    s_add_u32 s16, s16, s17
    s_lshl_b32 s17, s36, 5
    s_add_u32 s17, s17, s16
    s_lshl_b32 s49, s17, 11
    s_lshl_b32 s51, s33, 8
    s_add_u32 s49, s49, s51
    v_lshlrev_b32 v250, 11, v9
    v_lshl_add_u32 v250, v8, 4, v250
    v_add_u32 v250, s49, v250
    v_add_u32 v251, 8192, v250
    v_add_u32 v252, 16384, v250
    v_add_u32 v253, 24576, v250
    s_lshl_b32 s49, s48, 7
    s_add_u32 s49, s49, s69
    s_add_u32 s49, s49, 1572864
    v_lshrrev_b32 v29, 3, v1
    v_lshl_add_u32 v29, v29, 4, s49
    s_mov_b32 s40, 0xf0f0f0f0
    s_mov_b32 s41, 0xf0f0f0f0
    v_and_b32 v16, 1, v8
    v_add_u32 v17, v8, v16
    v_lshl_add_u32 v17, v9, 2, v17
    v_xor_b32 v16, 1, v16
    v_mul_u32_u24 v16, 4224, v16
    v_lshl_add_u32 v16, v17, 2, v16
    v_add_u32 v16, s65, v16
    v_and_b32 v17, 1, v8
    v_mul_u32_u24 v17, 4576, v17
    v_lshl_add_u32 v17, v9, 4, v17
    v_lshrrev_b32 v18, 1, v8
    v_lshlrev_b32 v18, 6, v18
    v_sub_u32 v17, v17, v18
    v_add_u32 v17, s66, v17
    v_add_u32 v17, 448, v17
    v_add_u32 v18, s66, v10
    s_load_dword s64, s[14:15], s50
    s_add_u32 s60, s12, s71
    s_addc_u32 s61, s13, 0
    s_cmp_lt_u32 s35, 28
    s_cselect_b32 s54, 260352, 0
    s_mov_b32 s55, 0x20000
    s_min_u32 s48, s35, 27
    s_lshl_b32 s48, s48, 18
    s_lshl_b32 s49, s33, 8
    s_add_u32 s48, s48, s49
    s_add_u32 s52, s24, s48
    s_addc_u32 s53, s25, 0
    v_lshlrev_b32 v25, 1, v9
    v_xor_b32 v25, v25, v8
    v_lshlrev_b32 v25, 4, v25
    s_lshl_b32 s48, s36, 2
    v_add_u32 v26, s48, v9
    v_lshl_add_u32 v242, v26, 11, v25
    s_lshr_b32 s48, s36, 1
    s_xor_b32 s48, s48, s36
    s_and_b32 s48, s48, 1
    s_lshl_b32 s48, s48, 7
    v_xor_b32 v242, s48, v242
    v_mov_b32 v226, v242
    s_lshl_b32 s68, s36, 10
    s_add_u32 s68, s68, 33792
    s_lshr_b32 s48, s36, 1
    s_and_b32 s49, s35, 2
    s_or_b32 s48, s48, s49
    v_bfe_u32 v25, v8, 1, 2
    v_xor_b32 v25, s48, v25
    v_and_b32 v247, 1, v9
    v_lshlrev_b32 v247, 6, v247
    v_lshl_add_u32 v247, v25, 4, v247
    v_and_b32 v25, 1, v8
    v_lshl_add_u32 v247, v25, 3, v247
    v_lshrrev_b32 v25, 3, v8
    v_lshl_add_u32 v246, v25, 18, v247
    v_lshrrev_b32 v25, 1, v9
    v_lshl_add_u32 v246, v25, 15, v246
    s_lshl_b32 s48, s35, 1
    s_lshr_b32 s49, s36, 1
    s_add_u32 s48, s48, s49
    s_and_b32 s49, s48, 0x30
    s_add_u32 s48, s48, s49
    s_lshl_b32 s48, s48, 11
    s_and_b32 s49, s36, 1
    s_lshl_b32 s49, s49, 7
    s_add_u32 s48, s48, s49
    s_lshl_b32 s49, s33, 8
    s_add_u32 s48, s48, s49
    v_add_u32 v246, s48, v246
    s_mov_b32 s67, 0xfffeffff
    s_getreg_b32 s3, hwreg(HW_REG_XCC_ID, 0, 4)
    s_lshl_b32 s3, s3, 28
    s_waitcnt lgkmcnt(0)
    s_add_u32 s38, s38, 1
    s_mul_i32 s43, s38, 0x9e3779b1
    s_add_u32 s43, s43, 0x7f4a7c15
    s_xor_b32 s43, s43, s3
    s_and_b32 s48, s36, 1
    s_lshl_b32 s48, s48, 4
    s_lshr_b32 s64, s64, s48
    s_and_b32 s64, s64, 0xffff
    v_mov_b32 v24, s64
    v_cmp_eq_u32 vcc, 15, v19
    s_nop 1
    v_cndmask_b32 v20, 0, v24, vcc
    v_cmp_eq_u32 vcc, 14, v19
    s_nop 1
    v_cndmask_b32 v21, 0, v24, vcc
    v_cmp_eq_u32 vcc, 13, v19
    s_nop 1
    v_cndmask_b32 v22, 0, v24, vcc
    v_cmp_eq_u32 vcc, 12, v19
    s_nop 1
    v_cndmask_b32 v23, 0, v24, vcc
    s_mov_b32 s48, 0
M_is:
    ds_read_b32 v26, v14 offset:80
    s_add_u32 s48, s48, 1
    s_waitcnt lgkmcnt(0)
    v_cmp_gt_u32 vcc, 4, v26
    s_cbranch_vccz M_is_d
    s_cmp_ge_u32 s48, 2000000
    s_cbranch_scc1 M_is_d
    s_branch M_is
M_is_d:
    s_lshl_b32 s48, s35, 9
    s_add_u32 s48, s48, 1703936
    s_lshl_b32 s49, s35, 10
    s_add_u32 s49, s49, 1719808
    v_mov_b32 v25, s48
    v_mov_b32 v26, s49
    v_cmp_gt_u32 vcc, 4, v1
    s_nop 1
    v_cndmask_b32 v25, v26, v25, vcc
    v_lshl_add_u32 v25, v1, 7, v25
    v_mov_b32 v26, 1753216
    v_cmp_gt_u32 vcc, 12, v1
    s_nop 1
    v_cndmask_b32 v25, v26, v25, vcc
    v_add_u32 v25, s69, v25
    s_lshl_b32 s48, s33, 8
    v_and_b32 v26, 3, v1
    v_lshl_add_u32 v26, v26, 20, s48
    global_load_dword v24, v25, s[30:31] sc1
    global_load_dword v24, v26, s[26:27] sc1
    s_lshl_b32 s51, s33, 5
    v_mov_b32 v26, s51
    global_load_dword v24, v26, s[28:29] sc1
    buffer_load_dwordx4 v[96:99], v10, s[60:63], 0 offen offset:0 nt
    buffer_load_dwordx4 v[100:103], v10, s[60:63], 0 offen offset:1024 nt
    buffer_load_dwordx4 v[104:107], v10, s[60:63], 0 offen offset:2048 nt
    buffer_load_dwordx4 v[108:111], v10, s[60:63], 0 offen offset:3072 nt
    v_mov_b32 v11, 0
    ds_write_b32 v12, v11
    v_add_u32 v12, s65, v10
    v_add_u32 v13, 4284, v12
    s_waitcnt vmcnt(3)
    ds_write_b128 v12, v[96:99] offset:64
    ds_write2_b32 v13, v96, v97 offset0:0 offset1:1
    ds_write2_b32 v13, v98, v99 offset0:2 offset1:3
    v_add_u32 v13, 1024, v13
    s_waitcnt vmcnt(2)
    ds_write_b128 v12, v[100:103] offset:1088
    ds_write2_b32 v13, v100, v101 offset0:0 offset1:1
    ds_write2_b32 v13, v102, v103 offset0:2 offset1:3
    v_add_u32 v13, 1024, v13
    s_waitcnt vmcnt(1)
    ds_write_b128 v12, v[104:107] offset:2112
    ds_write2_b32 v13, v104, v105 offset0:0 offset1:1
    ds_write2_b32 v13, v106, v107 offset0:2 offset1:3
    v_add_u32 v13, 1024, v13
    s_waitcnt vmcnt(0)
    ds_write_b128 v12, v[108:111] offset:3136
    ds_write2_b32 v13, v108, v109 offset0:0 offset1:1
    ds_write2_b32 v13, v110, v111 offset0:2 offset1:3
    ds_read_b64 v[64:65], v16 offset:0
    ds_read_b64 v[66:67], v16 offset:8
    ds_read_b64 v[68:69], v16 offset:512
    ds_read_b64 v[70:71], v16 offset:520
    ds_read_b64 v[72:73], v16 offset:1024
    ds_read_b64 v[74:75], v16 offset:1032
    ds_read_b64 v[76:77], v16 offset:1536
    ds_read_b64 v[78:79], v16 offset:1544
    ds_read_b64 v[80:81], v16 offset:2048
    ds_read_b64 v[82:83], v16 offset:2056
    ds_read_b64 v[84:85], v16 offset:2560
    ds_read_b64 v[86:87], v16 offset:2568
    ds_read_b64 v[88:89], v16 offset:3072
    ds_read_b64 v[90:91], v16 offset:3080
    ds_read_b64 v[92:93], v16 offset:3584
    ds_read_b64 v[94:95], v16 offset:3592
    v_add_u32 v16, 64, v16
    s_mov_b32 s48, 0
M_own:
    ds_read_b32 v26, v14 offset:4
    s_add_u32 s48, s48, 1
    s_waitcnt lgkmcnt(0)
    v_cmp_gt_u32 vcc, 4, v26
    s_cbranch_vccz M_own_d
    s_cmp_ge_u32 s48, 2000000
    s_cbranch_scc1 M_own_d
    s_sleep 1
    s_branch M_own
M_own_d:
    s_sleep 4
    global_load_dwordx4 v[140:143], v253, s[26:27] sc1
    global_load_dwordx4 v[136:139], v252, s[26:27] sc1
    global_load_dwordx4 v[132:135], v251, s[26:27] sc1
    global_load_dwordx4 v[128:131], v250, s[26:27] sc1
    global_load_dwordx4 v[160:163], v29, s[30:31] sc1
    s_mov_b64 exec, 1
    ds_add_u32 v14, v15 offset:76
    s_mov_b64 exec, -1
    s_mov_b32 s50, 0
M_up:
    s_waitcnt vmcnt(4)
    ds_write_b128 v18, v[140:143] offset:7648
    s_waitcnt vmcnt(3)
    ds_write_b128 v18, v[136:139] offset:6624
    s_waitcnt vmcnt(2)
    ds_write_b128 v18, v[132:135] offset:5600
    s_waitcnt vmcnt(1)
    ds_write_b128 v18, v[128:131] offset:4576
    v_alignbit_b32 v164, v131, v131, 9
    v_alignbit_b32 v165, v135, v135, 9
    v_alignbit_b32 v166, v139, v139, 9
    v_alignbit_b32 v167, v143, v143, 9
    v_add3_u32 v164, v128, v129, v164
    v_add3_u32 v165, v132, v133, v165
    v_add3_u32 v166, v136, v137, v166
    v_add3_u32 v167, v140, v141, v167
    v_add_u32 v164, v130, v164
    v_add_u32 v165, v134, v165
    v_add_u32 v166, v138, v166
    v_add_u32 v167, v142, v167
    v_add_u32_dpp v164, v164, v164 row_half_mirror row_mask:0xf bank_mask:0x5
    v_add_u32_dpp v166, v166, v166 row_half_mirror row_mask:0xf bank_mask:0x5
    s_nop 0
    v_add_u32_dpp v164, v165, v165 row_half_mirror row_mask:0xf bank_mask:0xa
    v_add_u32_dpp v166, v167, v167 row_half_mirror row_mask:0xf bank_mask:0xa
    s_nop 0
    v_add_u32_dpp v164, v164, v164 quad_perm:[2,3,0,1] row_mask:0xf bank_mask:0xf
    v_add_u32_dpp v166, v166, v166 quad_perm:[2,3,0,1] row_mask:0xf bank_mask:0xf
    s_nop 0
    v_add_u32_dpp v164, v164, v164 quad_perm:[1,0,3,2] row_mask:0xf bank_mask:0xf
    v_add_u32_dpp v166, v166, v166 quad_perm:[1,0,3,2] row_mask:0xf bank_mask:0xf
    s_waitcnt vmcnt(0)
    v_cndmask_b32 v26, v160, v161, s[40:41]
    v_cndmask_b32 v27, v162, v163, s[40:41]
    v_bitop3_b32 v26, v26, v164, s43 bitop3:0x96
    v_bitop3_b32 v27, v27, v166, s43 bitop3:0x96
    v_or_b32 v25, v26, v27
    v_cmp_ne_u32 vcc, 0, v25
    v_mov_b32 v159, 0
    s_cbranch_vccnz M_uretry
    s_mov_b64 exec, 1
    ds_add_u32 v14, v15 offset:8
    s_mov_b64 exec, -1
    v_readfirstlane_b32 s47, v140
    v_readfirstlane_b32 s46, v136
    v_readfirstlane_b32 s45, v132
    v_mov_b32 v155, s47
    v_mov_b32 v151, s46
    v_mov_b32 v147, s45
    v_mov_b32_dpp v159, v140 wave_shl:1 row_mask:0xf bank_mask:0xf
    v_mov_b32_dpp v155, v136 wave_shl:1 row_mask:0xf bank_mask:0xf
    v_mov_b32_dpp v151, v132 wave_shl:1 row_mask:0xf bank_mask:0xf
    v_mov_b32_dpp v147, v128 wave_shl:1 row_mask:0xf bank_mask:0xf
    v_alignbit_b32 v156, v141, v140, 16
    v_alignbit_b32 v157, v142, v141, 16
    v_alignbit_b32 v158, v143, v142, 16
    v_alignbit_b32 v159, v159, v143, 16
    ds_write_b128 v18, v[156:159] offset:3072
    v_alignbit_b32 v152, v137, v136, 16
    v_alignbit_b32 v153, v138, v137, 16
    v_alignbit_b32 v154, v139, v138, 16
    v_alignbit_b32 v155, v155, v139, 16
    ds_write_b128 v18, v[152:155] offset:2048
    v_alignbit_b32 v148, v133, v132, 16
    v_alignbit_b32 v149, v134, v133, 16
    v_alignbit_b32 v150, v135, v134, 16
    v_alignbit_b32 v151, v151, v135, 16
    ds_write_b128 v18, v[148:151] offset:1024
    v_alignbit_b32 v144, v129, v128, 16
    v_alignbit_b32 v145, v130, v129, 16
    v_alignbit_b32 v146, v131, v130, 16
    v_alignbit_b32 v147, v147, v131, 16
    ds_write_b128 v18, v[144:147] offset:0
    s_waitcnt lgkmcnt(0)
M_udone:
    ds_read_b128 v[128:131], v17 offset:3584
    ds_read_b128 v[132:135], v17 offset:3072
    ds_read_b128 v[136:139], v17 offset:2560
    ds_read_b128 v[140:143], v17 offset:2048
    ds_read_b128 v[144:147], v17 offset:1536
    ds_read_b128 v[148:151], v17 offset:1024
    ds_read_b128 v[152:155], v17 offset:512
    ds_read_b128 v[156:159], v17 offset:0
    v_add_u32 v17, 64, v17
    s_waitcnt lgkmcnt(7)
    v_mfma_f32_16x16x32_bf16 v[32:35], v[20:23], v[128:131], 0
    s_waitcnt lgkmcnt(6)
    v_mfma_f32_16x16x32_bf16 v[36:39], v[20:23], v[132:135], 0
    s_waitcnt lgkmcnt(5)
    v_mfma_f32_16x16x32_bf16 v[40:43], v[20:23], v[136:139], 0
    s_waitcnt lgkmcnt(4)
    v_mfma_f32_16x16x32_bf16 v[44:47], v[20:23], v[140:143], 0
    s_waitcnt lgkmcnt(3)
    v_mfma_f32_16x16x32_bf16 v[48:51], v[20:23], v[144:147], 0
    s_waitcnt lgkmcnt(2)
    v_mfma_f32_16x16x32_bf16 v[52:55], v[20:23], v[148:151], 0
    s_waitcnt lgkmcnt(1)
    v_mfma_f32_16x16x32_bf16 v[56:59], v[20:23], v[152:155], 0
    s_waitcnt lgkmcnt(0)
    v_mfma_f32_16x16x32_bf16 v[60:63], v[20:23], v[156:159], 0
    s_setprio 3
    s_mov_b32 s48, 0
M_conv:
    v_mfma_f32_16x16x32_bf16 v[60:63], v[64:67], v[156:159], v[60:63]
    ds_read_b64 v[96:97], v16 offset:0
    v_mfma_f32_16x16x32_bf16 v[60:63], v[68:71], v[152:155], v[60:63]
    ds_read_b64 v[98:99], v16 offset:8
    v_mfma_f32_16x16x32_bf16 v[60:63], v[72:75], v[148:151], v[60:63]
    ds_read_b128 v[160:163], v17 offset:3584
    v_mfma_f32_16x16x32_bf16 v[60:63], v[76:79], v[144:147], v[60:63]
    ds_read_b128 v[164:167], v17 offset:3072
    v_mfma_f32_16x16x32_bf16 v[60:63], v[80:83], v[140:143], v[60:63]
    ds_read_b128 v[168:171], v17 offset:2560
    v_mfma_f32_16x16x32_bf16 v[60:63], v[84:87], v[136:139], v[60:63]
    ds_read_b128 v[172:175], v17 offset:2048
    v_mfma_f32_16x16x32_bf16 v[60:63], v[88:91], v[132:135], v[60:63]
    ds_read_b128 v[176:179], v17 offset:1536
    v_mfma_f32_16x16x32_bf16 v[60:63], v[92:95], v[128:131], v[60:63]
    ds_read_b128 v[180:183], v17 offset:1024
    v_mfma_f32_16x16x32_bf16 v[56:59], v[88:91], v[128:131], v[56:59]
    ds_read_b128 v[184:187], v17 offset:512
    v_mfma_f32_16x16x32_bf16 v[56:59], v[84:87], v[132:135], v[56:59]
    ds_read_b128 v[188:191], v17 offset:0
    v_mfma_f32_16x16x32_bf16 v[56:59], v[80:83], v[136:139], v[56:59]
    ds_read_b64 v[100:101], v16 offset:512
    v_mfma_f32_16x16x32_bf16 v[56:59], v[76:79], v[140:143], v[56:59]
    ds_read_b64 v[102:103], v16 offset:520
    v_mfma_f32_16x16x32_bf16 v[56:59], v[72:75], v[144:147], v[56:59]
    ds_read_b64 v[104:105], v16 offset:1024
    v_mfma_f32_16x16x32_bf16 v[56:59], v[68:71], v[148:151], v[56:59]
    ds_read_b64 v[106:107], v16 offset:1032
    v_mfma_f32_16x16x32_bf16 v[56:59], v[64:67], v[152:155], v[56:59]
    ds_read_b64 v[108:109], v16 offset:1536
    v_mfma_f32_16x16x32_bf16 v[52:55], v[64:67], v[148:151], v[52:55]
    ds_read_b64 v[110:111], v16 offset:1544
    v_mfma_f32_16x16x32_bf16 v[52:55], v[68:71], v[144:147], v[52:55]
    ds_read_b64 v[112:113], v16 offset:2048
    v_mfma_f32_16x16x32_bf16 v[52:55], v[72:75], v[140:143], v[52:55]
    ds_read_b64 v[114:115], v16 offset:2056
    v_mfma_f32_16x16x32_bf16 v[52:55], v[76:79], v[136:139], v[52:55]
    ds_read_b64 v[116:117], v16 offset:2560
    v_mfma_f32_16x16x32_bf16 v[52:55], v[80:83], v[132:135], v[52:55]
    ds_read_b64 v[118:119], v16 offset:2568
    v_mfma_f32_16x16x32_bf16 v[52:55], v[84:87], v[128:131], v[52:55]
    ds_read_b64 v[120:121], v16 offset:3072
    v_mfma_f32_16x16x32_bf16 v[48:51], v[80:83], v[128:131], v[48:51]
    ds_read_b64 v[122:123], v16 offset:3080
    v_mfma_f32_16x16x32_bf16 v[48:51], v[76:79], v[132:135], v[48:51]
    ds_read_b64 v[124:125], v16 offset:3584
    v_mfma_f32_16x16x32_bf16 v[48:51], v[72:75], v[136:139], v[48:51]
    ds_read_b64 v[126:127], v16 offset:3592
    v_mfma_f32_16x16x32_bf16 v[48:51], v[68:71], v[140:143], v[48:51]
    v_mfma_f32_16x16x32_bf16 v[48:51], v[64:67], v[144:147], v[48:51]
    v_mfma_f32_16x16x32_bf16 v[44:47], v[64:67], v[140:143], v[44:47]
    v_mfma_f32_16x16x32_bf16 v[44:47], v[68:71], v[136:139], v[44:47]
    v_add_u32 v16, 64, v16
    v_add_u32 v17, 64, v17
    v_mfma_f32_16x16x32_bf16 v[44:47], v[72:75], v[132:135], v[44:47]
    v_mfma_f32_16x16x32_bf16 v[44:47], v[76:79], v[128:131], v[44:47]
    v_mfma_f32_16x16x32_bf16 v[40:43], v[72:75], v[128:131], v[40:43]
    v_mfma_f32_16x16x32_bf16 v[40:43], v[68:71], v[132:135], v[40:43]
    v_mfma_f32_16x16x32_bf16 v[40:43], v[64:67], v[136:139], v[40:43]
    v_mfma_f32_16x16x32_bf16 v[36:39], v[64:67], v[132:135], v[36:39]
    v_mfma_f32_16x16x32_bf16 v[36:39], v[68:71], v[128:131], v[36:39]
    v_mfma_f32_16x16x32_bf16 v[32:35], v[64:67], v[128:131], v[32:35]
    s_waitcnt lgkmcnt(0)
    v_mfma_f32_16x16x32_bf16 v[32:35], v[96:99], v[160:163], v[32:35]
    ds_read_b64 v[64:65], v16 offset:0
    v_mfma_f32_16x16x32_bf16 v[36:39], v[96:99], v[164:167], v[36:39]
    ds_read_b64 v[66:67], v16 offset:8
    v_mfma_f32_16x16x32_bf16 v[36:39], v[100:103], v[160:163], v[36:39]
    ds_read_b128 v[128:131], v17 offset:3584
    v_mfma_f32_16x16x32_bf16 v[40:43], v[104:107], v[160:163], v[40:43]
    ds_read_b128 v[132:135], v17 offset:3072
    v_mfma_f32_16x16x32_bf16 v[40:43], v[100:103], v[164:167], v[40:43]
    ds_read_b128 v[136:139], v17 offset:2560
    v_mfma_f32_16x16x32_bf16 v[40:43], v[96:99], v[168:171], v[40:43]
    ds_read_b128 v[140:143], v17 offset:2048
    v_mfma_f32_16x16x32_bf16 v[44:47], v[96:99], v[172:175], v[44:47]
    ds_read_b128 v[144:147], v17 offset:1536
    v_mfma_f32_16x16x32_bf16 v[44:47], v[100:103], v[168:171], v[44:47]
    ds_read_b128 v[148:151], v17 offset:1024
    v_mfma_f32_16x16x32_bf16 v[44:47], v[104:107], v[164:167], v[44:47]
    ds_read_b128 v[152:155], v17 offset:512
    v_mfma_f32_16x16x32_bf16 v[44:47], v[108:111], v[160:163], v[44:47]
    ds_read_b128 v[156:159], v17 offset:0
    v_mfma_f32_16x16x32_bf16 v[48:51], v[112:115], v[160:163], v[48:51]
    ds_read_b64 v[68:69], v16 offset:512
    v_mfma_f32_16x16x32_bf16 v[48:51], v[108:111], v[164:167], v[48:51]
    ds_read_b64 v[70:71], v16 offset:520
    v_mfma_f32_16x16x32_bf16 v[48:51], v[104:107], v[168:171], v[48:51]
    ds_read_b64 v[72:73], v16 offset:1024
    v_mfma_f32_16x16x32_bf16 v[48:51], v[100:103], v[172:175], v[48:51]
    ds_read_b64 v[74:75], v16 offset:1032
    v_mfma_f32_16x16x32_bf16 v[48:51], v[96:99], v[176:179], v[48:51]
    ds_read_b64 v[76:77], v16 offset:1536
    v_mfma_f32_16x16x32_bf16 v[52:55], v[96:99], v[180:183], v[52:55]
    ds_read_b64 v[78:79], v16 offset:1544
    v_mfma_f32_16x16x32_bf16 v[52:55], v[100:103], v[176:179], v[52:55]
    ds_read_b64 v[80:81], v16 offset:2048
    v_mfma_f32_16x16x32_bf16 v[52:55], v[104:107], v[172:175], v[52:55]
    ds_read_b64 v[82:83], v16 offset:2056
    v_mfma_f32_16x16x32_bf16 v[52:55], v[108:111], v[168:171], v[52:55]
    ds_read_b64 v[84:85], v16 offset:2560
    v_mfma_f32_16x16x32_bf16 v[52:55], v[112:115], v[164:167], v[52:55]
    ds_read_b64 v[86:87], v16 offset:2568
    v_mfma_f32_16x16x32_bf16 v[52:55], v[116:119], v[160:163], v[52:55]
    ds_read_b64 v[88:89], v16 offset:3072
    v_mfma_f32_16x16x32_bf16 v[56:59], v[120:123], v[160:163], v[56:59]
    ds_read_b64 v[90:91], v16 offset:3080
    v_mfma_f32_16x16x32_bf16 v[56:59], v[116:119], v[164:167], v[56:59]
    ds_read_b64 v[92:93], v16 offset:3584
    v_mfma_f32_16x16x32_bf16 v[56:59], v[112:115], v[168:171], v[56:59]
    ds_read_b64 v[94:95], v16 offset:3592
    v_mfma_f32_16x16x32_bf16 v[56:59], v[108:111], v[172:175], v[56:59]
    v_mfma_f32_16x16x32_bf16 v[56:59], v[104:107], v[176:179], v[56:59]
    v_mfma_f32_16x16x32_bf16 v[56:59], v[100:103], v[180:183], v[56:59]
    v_mfma_f32_16x16x32_bf16 v[56:59], v[96:99], v[184:187], v[56:59]
    v_add_u32 v16, 64, v16
    v_add_u32 v17, 64, v17
    v_mfma_f32_16x16x32_bf16 v[60:63], v[96:99], v[188:191], v[60:63]
    v_mfma_f32_16x16x32_bf16 v[60:63], v[100:103], v[184:187], v[60:63]
    v_mfma_f32_16x16x32_bf16 v[60:63], v[104:107], v[180:183], v[60:63]
    v_mfma_f32_16x16x32_bf16 v[60:63], v[108:111], v[176:179], v[60:63]
    v_mfma_f32_16x16x32_bf16 v[60:63], v[112:115], v[172:175], v[60:63]
    v_mfma_f32_16x16x32_bf16 v[60:63], v[116:119], v[168:171], v[60:63]
    v_mfma_f32_16x16x32_bf16 v[60:63], v[120:123], v[164:167], v[60:63]
    v_mfma_f32_16x16x32_bf16 v[60:63], v[124:127], v[160:163], v[60:63]
    s_waitcnt lgkmcnt(0)
    s_add_u32 s48, s48, 1
    s_cmp_lt_u32 s48, 3
    s_cbranch_scc1 M_conv
    v_mfma_f32_16x16x32_bf16 v[60:63], v[64:67], v[156:159], v[60:63]
    ds_read_b64 v[96:97], v16 offset:0
    v_mfma_f32_16x16x32_bf16 v[60:63], v[68:71], v[152:155], v[60:63]
    ds_read_b64 v[98:99], v16 offset:8
    v_mfma_f32_16x16x32_bf16 v[60:63], v[72:75], v[148:151], v[60:63]
    ds_read_b128 v[160:163], v17 offset:3584
    v_mfma_f32_16x16x32_bf16 v[60:63], v[76:79], v[144:147], v[60:63]
    ds_read_b128 v[164:167], v17 offset:3072
    v_mfma_f32_16x16x32_bf16 v[60:63], v[80:83], v[140:143], v[60:63]
    ds_read_b128 v[168:171], v17 offset:2560
    v_mfma_f32_16x16x32_bf16 v[60:63], v[84:87], v[136:139], v[60:63]
    ds_read_b128 v[172:175], v17 offset:2048
    v_mfma_f32_16x16x32_bf16 v[60:63], v[88:91], v[132:135], v[60:63]
    ds_read_b128 v[176:179], v17 offset:1536
    v_mfma_f32_16x16x32_bf16 v[60:63], v[92:95], v[128:131], v[60:63]
    ds_read_b128 v[180:183], v17 offset:1024
    v_mfma_f32_16x16x32_bf16 v[56:59], v[88:91], v[128:131], v[56:59]
    ds_read_b128 v[184:187], v17 offset:512
    v_mfma_f32_16x16x32_bf16 v[56:59], v[84:87], v[132:135], v[56:59]
    ds_read_b128 v[188:191], v17 offset:0
    v_mfma_f32_16x16x32_bf16 v[56:59], v[80:83], v[136:139], v[56:59]
    ds_read_b64 v[100:101], v16 offset:512
    v_mfma_f32_16x16x32_bf16 v[56:59], v[76:79], v[140:143], v[56:59]
    ds_read_b64 v[102:103], v16 offset:520
    v_mfma_f32_16x16x32_bf16 v[56:59], v[72:75], v[144:147], v[56:59]
    ds_read_b64 v[104:105], v16 offset:1024
    v_mfma_f32_16x16x32_bf16 v[56:59], v[68:71], v[148:151], v[56:59]
    ds_read_b64 v[106:107], v16 offset:1032
    v_mfma_f32_16x16x32_bf16 v[56:59], v[64:67], v[152:155], v[56:59]
    ds_read_b64 v[108:109], v16 offset:1536
    v_mfma_f32_16x16x32_bf16 v[52:55], v[64:67], v[148:151], v[52:55]
    ds_read_b64 v[110:111], v16 offset:1544
    v_mfma_f32_16x16x32_bf16 v[52:55], v[68:71], v[144:147], v[52:55]
    ds_read_b64 v[112:113], v16 offset:2048
    v_mfma_f32_16x16x32_bf16 v[52:55], v[72:75], v[140:143], v[52:55]
    ds_read_b64 v[114:115], v16 offset:2056
    v_mfma_f32_16x16x32_bf16 v[52:55], v[76:79], v[136:139], v[52:55]
    ds_read_b64 v[116:117], v16 offset:2560
    v_mfma_f32_16x16x32_bf16 v[52:55], v[80:83], v[132:135], v[52:55]
    ds_read_b64 v[118:119], v16 offset:2568
    v_mfma_f32_16x16x32_bf16 v[52:55], v[84:87], v[128:131], v[52:55]
    ds_read_b64 v[120:121], v16 offset:3072
    v_mfma_f32_16x16x32_bf16 v[48:51], v[80:83], v[128:131], v[48:51]
    ds_read_b64 v[122:123], v16 offset:3080
    v_mfma_f32_16x16x32_bf16 v[48:51], v[76:79], v[132:135], v[48:51]
    ds_read_b64 v[124:125], v16 offset:3584
    v_mfma_f32_16x16x32_bf16 v[48:51], v[72:75], v[136:139], v[48:51]
    ds_read_b64 v[126:127], v16 offset:3592
    v_mfma_f32_16x16x32_bf16 v[48:51], v[68:71], v[140:143], v[48:51]
    v_mfma_f32_16x16x32_bf16 v[48:51], v[64:67], v[144:147], v[48:51]
    v_mfma_f32_16x16x32_bf16 v[44:47], v[64:67], v[140:143], v[44:47]
    v_mfma_f32_16x16x32_bf16 v[44:47], v[68:71], v[136:139], v[44:47]
    v_add_u32 v16, 64, v16
    v_add_u32 v17, 64, v17
    v_mfma_f32_16x16x32_bf16 v[44:47], v[72:75], v[132:135], v[44:47]
    v_mfma_f32_16x16x32_bf16 v[44:47], v[76:79], v[128:131], v[44:47]
    v_mfma_f32_16x16x32_bf16 v[40:43], v[72:75], v[128:131], v[40:43]
    v_mfma_f32_16x16x32_bf16 v[40:43], v[68:71], v[132:135], v[40:43]
    v_mfma_f32_16x16x32_bf16 v[40:43], v[64:67], v[136:139], v[40:43]
    v_mfma_f32_16x16x32_bf16 v[36:39], v[64:67], v[132:135], v[36:39]
    v_mfma_f32_16x16x32_bf16 v[36:39], v[68:71], v[128:131], v[36:39]
    v_mfma_f32_16x16x32_bf16 v[32:35], v[64:67], v[128:131], v[32:35]
    s_waitcnt lgkmcnt(0)
    s_lshl_b32 s51, s33, 5
    s_load_dwordx8 s[56:63], s[28:29], s51
    v_mfma_f32_16x16x32_bf16 v[32:35], v[96:99], v[160:163], v[32:35]
    v_mfma_f32_16x16x32_bf16 v[36:39], v[96:99], v[164:167], v[36:39]
    v_mfma_f32_16x16x32_bf16 v[36:39], v[100:103], v[160:163], v[36:39]
    v_mfma_f32_16x16x32_bf16 v[40:43], v[104:107], v[160:163], v[40:43]
    v_mfma_f32_16x16x32_bf16 v[40:43], v[100:103], v[164:167], v[40:43]
    v_mfma_f32_16x16x32_bf16 v[40:43], v[96:99], v[168:171], v[40:43]
    v_mfma_f32_16x16x32_bf16 v[44:47], v[96:99], v[172:175], v[44:47]
    v_mfma_f32_16x16x32_bf16 v[44:47], v[100:103], v[168:171], v[44:47]
    v_mfma_f32_16x16x32_bf16 v[44:47], v[104:107], v[164:167], v[44:47]
    v_mfma_f32_16x16x32_bf16 v[44:47], v[108:111], v[160:163], v[44:47]
    v_mfma_f32_16x16x32_bf16 v[48:51], v[112:115], v[160:163], v[48:51]
    v_mfma_f32_16x16x32_bf16 v[48:51], v[108:111], v[164:167], v[48:51]
    v_mfma_f32_16x16x32_bf16 v[48:51], v[104:107], v[168:171], v[48:51]
    s_waitcnt lgkmcnt(0)
    s_and_b64 s[56:57], s[56:57], s[58:59]
    s_and_b64 s[60:61], s[60:61], s[62:63]
    s_and_b64 s[56:57], s[56:57], s[60:61]
    s_and_b32 s48, s56, s57
    v_mfma_f32_16x16x32_bf16 v[48:51], v[100:103], v[172:175], v[48:51]
    s_mov_b64 s[56:57], s[26:27]
    s_mov_b32 s59, 0x20000
    s_cmp_eq_u32 s48, -1
    s_cselect_b32 s58, 0x400000, 0
    s_mov_b32 s39, 0
    v_mfma_f32_16x16x32_bf16 v[48:51], v[96:99], v[176:179], v[48:51]
    v_cvt_pk_bf16_f32 v64, v32, v33
    v_cvt_pk_bf16_f32 v65, v34, v35
    s_mov_b32 s49, 0
    v_mfma_f32_16x16x32_bf16 v[52:55], v[96:99], v[180:183], v[52:55]
    v_min_u32 v64, s67, v64
    buffer_store_dwordx2 v[64:65], v246, s[56:59], s49 offen
    v_mfma_f32_16x16x32_bf16 v[52:55], v[100:103], v[176:179], v[52:55]
    v_cvt_pk_bf16_f32 v66, v36, v37
    v_cvt_pk_bf16_f32 v67, v38, v39
    s_mov_b32 s49, 524288
    v_mfma_f32_16x16x32_bf16 v[52:55], v[104:107], v[172:175], v[52:55]
    v_min_u32 v66, s67, v66
    buffer_store_dwordx2 v[66:67], v246, s[56:59], s49 offen
    v_mfma_f32_16x16x32_bf16 v[52:55], v[108:111], v[168:171], v[52:55]
    v_cvt_pk_bf16_f32 v68, v40, v41
    v_cvt_pk_bf16_f32 v69, v42, v43
    s_mov_b32 s49, 1048576
    v_mfma_f32_16x16x32_bf16 v[52:55], v[112:115], v[164:167], v[52:55]
    v_min_u32 v68, s67, v68
    buffer_store_dwordx2 v[68:69], v246, s[56:59], s49 offen
    v_mfma_f32_16x16x32_bf16 v[52:55], v[116:119], v[160:163], v[52:55]
    v_cvt_pk_bf16_f32 v70, v44, v45
    v_cvt_pk_bf16_f32 v71, v46, v47
    s_mov_b32 s49, 1572864
    v_mfma_f32_16x16x32_bf16 v[56:59], v[120:123], v[160:163], v[56:59]
    v_min_u32 v70, s67, v70
    buffer_store_dwordx2 v[70:71], v246, s[56:59], s49 offen
    v_mfma_f32_16x16x32_bf16 v[56:59], v[116:119], v[164:167], v[56:59]
    v_cvt_pk_bf16_f32 v72, v48, v49
    v_cvt_pk_bf16_f32 v73, v50, v51
    s_mov_b32 s49, 2097152
    v_mfma_f32_16x16x32_bf16 v[56:59], v[112:115], v[168:171], v[56:59]
    v_min_u32 v72, s67, v72
    buffer_store_dwordx2 v[72:73], v246, s[56:59], s49 offen
    v_mfma_f32_16x16x32_bf16 v[56:59], v[108:111], v[172:175], v[56:59]
    v_cvt_pk_bf16_f32 v74, v52, v53
    v_cvt_pk_bf16_f32 v75, v54, v55
    s_mov_b32 s49, 2621440
    v_mfma_f32_16x16x32_bf16 v[56:59], v[104:107], v[176:179], v[56:59]
    v_min_u32 v74, s67, v74
    buffer_store_dwordx2 v[74:75], v246, s[56:59], s49 offen
    v_mfma_f32_16x16x32_bf16 v[56:59], v[100:103], v[180:183], v[56:59]
    v_mfma_f32_16x16x32_bf16 v[56:59], v[96:99], v[184:187], v[56:59]
    v_mfma_f32_16x16x32_bf16 v[60:63], v[96:99], v[188:191], v[60:63]
    v_mfma_f32_16x16x32_bf16 v[60:63], v[100:103], v[184:187], v[60:63]
    v_mfma_f32_16x16x32_bf16 v[60:63], v[104:107], v[180:183], v[60:63]
    v_mfma_f32_16x16x32_bf16 v[60:63], v[108:111], v[176:179], v[60:63]
    s_nop 3
    v_cvt_pk_bf16_f32 v76, v56, v57
    v_cvt_pk_bf16_f32 v77, v58, v59
    s_mov_b32 s49, 3145728
    v_mfma_f32_16x16x32_bf16 v[60:63], v[112:115], v[172:175], v[60:63]
    v_min_u32 v76, s67, v76
    buffer_store_dwordx2 v[76:77], v246, s[56:59], s49 offen
    v_mfma_f32_16x16x32_bf16 v[60:63], v[116:119], v[168:171], v[60:63]
    v_mfma_f32_16x16x32_bf16 v[60:63], v[120:123], v[164:167], v[60:63]
    v_mfma_f32_16x16x32_bf16 v[60:63], v[124:127], v[160:163], v[60:63]
    s_nop 7
    v_cvt_pk_bf16_f32 v78, v60, v61
    v_cvt_pk_bf16_f32 v79, v62, v63
    v_min_u32 v78, s67, v78
    s_mov_b32 s49, 3670016
    buffer_store_dwordx2 v[78:79], v246, s[56:59], s49 offen
    s_cmp_eq_u32 s58, 0
    s_cbranch_scc1 M_zlate
M_zd:
    s_mov_b64 exec, 1
    ds_add_u32 v14, v15 offset:68
    s_mov_b64 exec, -1
    s_setprio 0
    v_bfe_u32 v2, v1, 2, 2
    v_lshl_add_u32 v3, v9, 3, v2
    v_and_b32 v4, 1, v9
    v_lshl_add_u32 v2, v4, 2, v2
    s_lshl_b32 s48, s36, 1
    v_xor_b32 v2, s48, v2
    v_lshlrev_b32 v2, 5, v2
    v_lshl_add_u32 v2, v3, 8, v2
    v_and_b32 v3, 3, v1
    v_lshl_add_u32 v228, v3, 3, v2
    v_xor_b32 v229, 128, v228
    v_add_u32 v229, 1024, v229
    v_xor_b32 v230, 32, v228
    v_xor_b32 v231, 32, v229
    v_add_u32 v232, 70400, v228
    v_add_u32 v233, 70400, v229
    v_add_u32 v234, 70400, v230
    v_add_u32 v235, 70400, v231
    s_lshl_b32 s49, s36, 12
    s_add_u32 s48, s69, s49
    s_add_u32 s48, s48, 1703936
    v_add_u32 v236, s48, v10
    s_lshl_b32 s48, s36, 11
    s_add_u32 s48, s48, 152320
    v_lshl_add_u32 v237, v1, 3, s48
    v_lshlrev_b32 v238, 4, v9
    v_add_u32 v242, 160512, v238
    v_add_u32 v238, 152320, v238
    s_lshl_b32 s48, s35, 13
    s_lshl_b32 s49, s36, 11
    s_add_u32 s48, s48, s49
    s_add_u32 s48, s48, 17301504
    v_add_u32 v240, s48, v10
    s_lshl_b32 s49, s33, 8
    v_add_u32 v239, s49, v240
    v_lshrrev_b32 v2, 5, v1
    v_lshl_add_u32 v2, v2, 4, v8
    s_xor_b32 s48, s43, s3
    s_bfe_u32 s49, s48, 0x80000
    v_mov_b32 v88, s49
    s_bfe_u32 s49, s48, 0x80008
    v_mov_b32 v89, s49
    s_bfe_u32 s49, s48, 0x80010
    v_mov_b32 v90, s49
    s_bfe_u32 s49, s48, 0x80018
    v_mov_b32 v91, s49
    s_movk_i32 s42, 0xff
    s_lshl_b32 s48, s36, 6
    s_add_u32 s48, s48, 160512
    v_lshl_add_u32 v241, v2, 1, s48
    s_lshl_b32 s48, s35, 10
    s_add_u32 s48, s48, s69
    s_lshl_b32 s49, s36, 8
    s_add_u32 s48, s48, s49
    s_add_u32 s48, s48, 1720320
    v_lshl_add_u32 v243, v1, 4, s48
    v_mov_b32 v85, s38
    s_mov_b32 s48, 0
M_zdw:
    ds_read_b32 v26, v14 offset:44
    s_add_u32 s48, s48, 1
    s_waitcnt lgkmcnt(0)
    v_cmp_gt_u32 vcc, 4, v26
    s_cbranch_vccz M_zdw_d
    s_cmp_ge_u32 s48, 2000000
    s_cbranch_scc1 M_zdw_d
    s_sleep 1
    s_branch M_zdw
M_zdw_d:
    s_mov_b32 s49, 32768
    s_add_u32 m0, s68, 4096
    s_nop 0
    buffer_load_dwordx4 v226, s[52:55], s49 offen nt lds
    s_mov_b32 s49, 65536
    s_add_u32 m0, s68, 8192
    s_nop 0
    buffer_load_dwordx4 v226, s[52:55], s49 offen nt lds
    s_mov_b32 s49, 98304
    s_add_u32 m0, s68, 12288
    s_nop 0
    buffer_load_dwordx4 v226, s[52:55], s49 offen nt lds
    s_mov_b32 s49, 131072
    s_add_u32 m0, s68, 16384
    s_nop 0
    buffer_load_dwordx4 v226, s[52:55], s49 offen nt lds
    s_mov_b32 s49, 163840
    s_add_u32 m0, s68, 20480
    s_nop 0
    buffer_load_dwordx4 v226, s[52:55], s49 offen nt lds
    s_mov_b32 s48, 0
M_wl:
    ds_read_b32 v26, v14 offset:24
    s_add_u32 s48, s48, 1
    s_waitcnt lgkmcnt(0)
    v_cmp_gt_u32 vcc, 4, v26
    s_cbranch_vccz M_wl_d
    s_cmp_ge_u32 s48, 2000000
    s_cbranch_scc1 M_wl_d
    s_sleep 1
    s_branch M_wl
M_wl_d:
    ds_read_b64_tr_b16 v[128:129], v232 offset:0
    ds_read_b64_tr_b16 v[130:131], v233 offset:0
    ds_read_b64_tr_b16 v[132:133], v232 offset:8192
    ds_read_b64_tr_b16 v[134:135], v233 offset:8192
    ds_read_b64_tr_b16 v[136:137], v232 offset:16384
    ds_read_b64_tr_b16 v[138:139], v233 offset:16384
    ds_read_b64_tr_b16 v[140:141], v232 offset:24576
    ds_read_b64_tr_b16 v[142:143], v233 offset:24576
    ds_read_b64_tr_b16 v[144:145], v234 offset:0
    ds_read_b64_tr_b16 v[146:147], v235 offset:0
    ds_read_b64_tr_b16 v[148:149], v234 offset:8192
    ds_read_b64_tr_b16 v[150:151], v235 offset:8192
    ds_read_b64_tr_b16 v[152:153], v234 offset:16384
    ds_read_b64_tr_b16 v[154:155], v235 offset:16384
    ds_read_b64_tr_b16 v[156:157], v234 offset:24576
    ds_read_b64_tr_b16 v[158:159], v235 offset:24576
    ds_read_b64_tr_b16 v[160:161], v232 offset:32768
    ds_read_b64_tr_b16 v[162:163], v233 offset:32768
    ds_read_b64_tr_b16 v[164:165], v232 offset:40960
    ds_read_b64_tr_b16 v[166:167], v233 offset:40960
    ds_read_b64_tr_b16 v[168:169], v232 offset:49152
    ds_read_b64_tr_b16 v[170:171], v233 offset:49152
    ds_read_b64_tr_b16 v[172:173], v232 offset:57344
    ds_read_b64_tr_b16 v[174:175], v233 offset:57344
    ds_read_b64_tr_b16 v[176:177], v234 offset:32768
    ds_read_b64_tr_b16 v[178:179], v235 offset:32768
    ds_read_b64_tr_b16 v[180:181], v234 offset:40960
    ds_read_b64_tr_b16 v[182:183], v235 offset:40960
    ds_read_b64_tr_b16 v[184:185], v234 offset:49152
    ds_read_b64_tr_b16 v[186:187], v235 offset:49152
    ds_read_b64_tr_b16 v[188:189], v234 offset:57344
    ds_read_b64_tr_b16 v[190:191], v235 offset:57344
    s_waitcnt vmcnt(0)
    s_mov_b64 exec, 1
    ds_add_u32 v14, v15 offset:28
    s_mov_b64 exec, -1
    s_mov_b32 s48, 0
M_wl2:
    ds_read_b32 v26, v14 offset:28
    s_add_u32 s48, s48, 1
    s_waitcnt lgkmcnt(0)
    v_cmp_gt_u32 vcc, 8, v26
    s_cbranch_vccz M_wl2_d
    s_cmp_ge_u32 s48, 2000000
    s_cbranch_scc1 M_wl2_d
    s_sleep 1
    s_branch M_wl2
M_wl2_d:
    ds_read_b64_tr_b16 v[192:193], v228 offset:33792
    ds_read_b64_tr_b16 v[194:195], v229 offset:33792
    ds_read_b64_tr_b16 v[208:209], v230 offset:33792
    ds_read_b64_tr_b16 v[210:211], v231 offset:33792
    ds_read_b64_tr_b16 v[196:197], v228 offset:41984
    ds_read_b64_tr_b16 v[198:199], v229 offset:41984
    ds_read_b64_tr_b16 v[212:213], v230 offset:41984
    ds_read_b64_tr_b16 v[214:215], v231 offset:41984
    ds_read_b64_tr_b16 v[200:201], v228 offset:50176
    ds_read_b64_tr_b16 v[202:203], v229 offset:50176
    ds_read_b64_tr_b16 v[216:217], v230 offset:50176
    ds_read_b64_tr_b16 v[218:219], v231 offset:50176
    s_mov_b32 s48, 0
M_pub:
    ds_read_b32 v26, v14 offset:40
    s_add_u32 s48, s48, 1
    s_waitcnt lgkmcnt(0)
    v_cmp_gt_u32 vcc, 1, v26
    s_cbranch_vccz M_pub_d
    s_cmp_ge_u32 s48, 2000000
    s_cbranch_scc1 M_pub_d
    s_sleep 1
    s_branch M_pub
M_pub_d:
    s_setprio 3
    global_load_dwordx4 v[64:67], v236, s[30:31] offset:0 sc1
    global_load_dwordx4 v[68:71], v236, s[30:31] offset:1024 sc1
    global_load_dwordx4 v[72:75], v236, s[30:31] offset:2048 sc1
    global_load_dwordx4 v[76:79], v236, s[30:31] offset:3072 sc1
    s_mov_b32 s48, 0
M_p3_loop:
    s_waitcnt vmcnt(0)
    v_cmp_ne_u32 s[44:45], s38, v67
    v_cmp_ne_u32 s[46:47], s38, v71
    v_cmp_ne_u32 s[56:57], s38, v75
    v_cmp_ne_u32 s[58:59], s38, v79
    s_or_b64 vcc, s[44:45], s[46:47]
    s_or_b64 vcc, vcc, s[56:57]
    s_or_b64 vcc, vcc, s[58:59]
    s_cbranch_scc0 M_p3_done
    s_add_u32 s48, s48, 1
    s_cmp_ge_u32 s48, 100000
    s_cbranch_scc1 M_p3_done
    s_mov_b64 exec, s[44:45]
    global_load_dwordx4 v[64:67], v236, s[30:31] offset:0 sc1
    s_mov_b64 exec, s[46:47]
    global_load_dwordx4 v[68:71], v236, s[30:31] offset:1024 sc1
    s_mov_b64 exec, s[56:57]
    global_load_dwordx4 v[72:75], v236, s[30:31] offset:2048 sc1
    s_mov_b64 exec, s[58:59]
    global_load_dwordx4 v[76:79], v236, s[30:31] offset:3072 sc1
    s_mov_b64 exec, -1
    s_branch M_p3_loop
M_p3_done:
    v_max3_u32 v26, v66, v70, v74
    v_max_u32 v26, v26, v78
    ds_write_b64 v237, v[64:65] offset:0
    ds_write_b64 v237, v[68:69] offset:512
    ds_write_b64 v237, v[72:73] offset:1024
    ds_write_b64 v237, v[76:77] offset:1536
    s_mov_b32 s48, 1
    s_mov_b32 s49, 1
    s_mov_b64 exec, s[48:49]
    ds_max_u32 v14, v26 offset:52
    s_mov_b64 exec, 1
    ds_add_u32 v14, v15 offset:48
    s_mov_b64 exec, -1
    s_cmp_ge_u32 s35, 28
    s_cbranch_scc1 M_noffn
    s_mov_b32 s48, 0
M_rc:
    ds_read_b64 v[26:27], v14 offset:48
    s_add_u32 s48, s48, 1
    s_waitcnt lgkmcnt(0)
    v_cmp_gt_u32 vcc, 4, v26
    s_cbranch_vccz M_rc_d
    s_cmp_ge_u32 s48, 2000000
    s_cbranch_scc1 M_rc_d
    s_branch M_rc
M_rc_d:
    v_not_b32 v27, v27
    v_bfe_u32 v26, v27, 7, 4
    v_bfe_u32 v27, v27, 4, 1
    v_lshl_add_u32 v26, v26, 9, v238
    v_lshl_add_u32 v27, v27, 8, v26
    ds_read_b128 v[32:35], v27 offset:0
    ds_read_b128 v[36:39], v27 offset:64
    ds_read_b128 v[40:43], v27 offset:128
    ds_read_b128 v[44:47], v27 offset:192
    s_mov_b32 s49, 196608
    s_add_u32 m0, s68, 24576
    s_nop 0
    buffer_load_dwordx4 v226, s[52:55], s49 offen nt lds
    s_mov_b32 s49, 229376
    s_add_u32 m0, s68, 28672
    s_nop 0
    buffer_load_dwordx4 v226, s[52:55], s49 offen nt lds
    s_waitcnt lgkmcnt(3)
    v_mfma_f32_16x16x32_bf16 v[48:51], v[32:35], v[128:131], 0
    v_mfma_f32_16x16x32_bf16 v[52:55], v[32:35], v[144:147], 0
    v_mfma_f32_16x16x32_bf16 v[56:59], v[32:35], v[160:163], 0
    v_mfma_f32_16x16x32_bf16 v[60:63], v[32:35], v[176:179], 0
    s_waitcnt lgkmcnt(2)
    v_mfma_f32_16x16x32_bf16 v[48:51], v[36:39], v[132:135], v[48:51]
    v_mfma_f32_16x16x32_bf16 v[52:55], v[36:39], v[148:151], v[52:55]
    v_mfma_f32_16x16x32_bf16 v[56:59], v[36:39], v[164:167], v[56:59]
    v_mfma_f32_16x16x32_bf16 v[60:63], v[36:39], v[180:183], v[60:63]
    s_waitcnt lgkmcnt(1)
    v_mfma_f32_16x16x32_bf16 v[48:51], v[40:43], v[136:139], v[48:51]
    v_mfma_f32_16x16x32_bf16 v[52:55], v[40:43], v[152:155], v[52:55]
    v_mfma_f32_16x16x32_bf16 v[56:59], v[40:43], v[168:171], v[56:59]
    v_mfma_f32_16x16x32_bf16 v[60:63], v[40:43], v[184:187], v[60:63]
    s_waitcnt lgkmcnt(0)
    v_mfma_f32_16x16x32_bf16 v[48:51], v[44:47], v[140:143], v[48:51]
    v_mfma_f32_16x16x32_bf16 v[52:55], v[44:47], v[156:159], v[52:55]
    v_mfma_f32_16x16x32_bf16 v[56:59], v[44:47], v[172:175], v[56:59]
    v_mfma_f32_16x16x32_bf16 v[60:63], v[44:47], v[188:191], v[60:63]
    s_nop 4
    v_bfi_b32 v80, s42, v88, v48
    s_nop 0
    v_bfi_b32 v81, s42, v89, v56
    v_bfi_b32 v82, s42, v90, v52
    v_bfi_b32 v83, s42, v91, v60
    s_mov_b64 exec, 0xffff
    global_store_dwordx4 v239, v[80:83], s[30:31] sc1
    s_mov_b64 exec, 1
    ds_add_u32 v14, v15 offset:76
    s_mov_b64 exec, -1
    s_sleep 11
    s_mov_b32 s48, 0
M_pm_loop:
    global_load_dwordx4 v[64:67], v240, s[30:31] offset:0 sc1
    global_load_dwordx4 v[68:71], v240, s[30:31] offset:1024 sc1
    s_add_u32 s48, s48, 1
    s_waitcnt vmcnt(0)
    v_xor_b32 v64, v88, v64
    v_xor_b32 v65, v89, v65
    v_xor_b32 v66, v90, v66
    v_xor_b32 v67, v91, v67
    v_xor_b32 v68, v88, v68
    v_xor_b32 v69, v89, v69
    v_xor_b32 v70, v90, v70
    v_xor_b32 v71, v91, v71
    v_or3_b32 v26, v64, v65, v66
    v_or3_b32 v27, v67, v68, v69
    v_or3_b32 v26, v26, v70, v71
    v_bitop3_b32 v26, v26, v27, s42 bitop3:0xa8
    v_cmp_ne_u32 vcc, 0, v26
    s_cbranch_vccz M_pm_done
    s_cmp_ge_u32 s48, 100000
    s_cbranch_scc1 M_pm_done
    s_sleep 1
    s_branch M_pm_loop
M_pm_done:
    v_pk_add_f32 v[64:65], v[64:65], v[68:69]
    v_pk_add_f32 v[66:67], v[66:67], v[70:71]
    s_nop 1
    v_permlane32_swap_b32 v64, v66
    v_permlane32_swap_b32 v65, v67
    v_pk_add_f32 v[64:65], v[64:65], v[66:67]
    v_mov_b32 v66, v64
    v_mov_b32 v67, v65
    s_nop 0
    v_permlane16_swap_b32 v64, v66
    v_permlane16_swap_b32 v65, v67
    v_pk_add_f32 v[64:65], v[64:65], v[66:67]
    v_cvt_pk_bf16_f32 v66, v64, v65
    v_lshlrev_b32 v64, 16, v66
    v_and_b32 v65, s34, v66
    v_mul_f32 v66, 0xbfb8aa3b, v64
    v_exp_f32 v66, v66
    s_nop 0
    v_add_f32 v66, 1.0, v66
    v_rcp_f32 v66, v66
    s_nop 0
    v_mul_f32 v66, v66, v64
    v_cvt_pk_bf16_f32 v66, v66, v66
    v_and_b32 v66, s34, v66
    v_mul_f32 v66, v66, v65
    v_cvt_pk_bf16_f32 v66, v66, v66
    ds_write_b16 v241, v66
    s_mov_b64 exec, 1
    ds_add_u32 v14, v15 offset:56
    s_mov_b64 exec, -1
    s_mov_b32 s48, 0
M_act:
    ds_read_b32 v26, v14 offset:56
    s_add_u32 s48, s48, 1
    s_waitcnt lgkmcnt(0)
    v_cmp_gt_u32 vcc, 4, v26
    s_cbranch_vccz M_act_d
    s_cmp_ge_u32 s48, 2000000
    s_cbranch_scc1 M_act_d
    s_branch M_act
M_act_d:
    ds_read_b128 v[32:35], v242 offset:0
    ds_read_b128 v[36:39], v242 offset:64
    ds_read_b128 v[40:43], v242 offset:128
    ds_read_b128 v[44:47], v242 offset:192
    ds_read_b64_tr_b16 v[204:205], v228 offset:58368
    ds_read_b64_tr_b16 v[206:207], v229 offset:58368
    ds_read_b64_tr_b16 v[220:221], v230 offset:58368
    ds_read_b64_tr_b16 v[222:223], v231 offset:58368
    s_waitcnt lgkmcnt(7)
    v_mfma_f32_16x16x32_bf16 v[48:51], v[32:35], v[192:195], 0
    v_mfma_f32_16x16x32_bf16 v[52:55], v[32:35], v[208:211], 0
    s_waitcnt lgkmcnt(6)
    v_mfma_f32_16x16x32_bf16 v[48:51], v[36:39], v[196:199], v[48:51]
    v_mfma_f32_16x16x32_bf16 v[52:55], v[36:39], v[212:215], v[52:55]
    s_waitcnt lgkmcnt(5)
    v_mfma_f32_16x16x32_bf16 v[48:51], v[40:43], v[200:203], v[48:51]
    v_mfma_f32_16x16x32_bf16 v[52:55], v[40:43], v[216:219], v[52:55]
    s_waitcnt lgkmcnt(0)
    v_mfma_f32_16x16x32_bf16 v[48:51], v[44:47], v[204:207], v[48:51]
    v_mfma_f32_16x16x32_bf16 v[52:55], v[44:47], v[220:223], v[52:55]
    s_nop 7
    v_mov_b32 v49, v52
    v_mov_b32 v50, s38
    s_mov_b64 exec, 0xffff
    s_cmp_lg_u32 s39, 0
    s_cbranch_scc1 M_ptg
    global_store_dwordx4 v243, v[48:51], s[30:31]
M_ptd:
    s_mov_b64 exec, 1
    ds_add_u32 v14, v15 offset:60
    s_mov_b64 exec, -1
    s_cmp_lg_u32 s2, 0
    s_cbranch_scc1 B_fin
    s_cmp_lg_u32 s36, 0
    s_cbranch_scc1 B_fin
    s_mov_b64 exec, 1
    v_mov_b32 v2, 17760256
    global_store_dword v2, v85, s[30:31] sc1
    s_branch B_fin
M_noffn:
    s_mov_b64 exec, 1
    ds_add_u32 v14, v15 offset:56
    s_mov_b64 exec, -1
    s_mov_b64 exec, 1
    ds_add_u32 v14, v15 offset:76
    s_mov_b64 exec, -1
    s_sleep 24
    s_mov_b64 exec, 1
    ds_add_u32 v14, v15 offset:60
    s_mov_b64 exec, -1
    s_branch B_fin
M_ptg:
    global_store_dwordx4 v243, v[48:51], s[30:31] sc1
    s_branch M_ptd
M_zlate:
    s_mov_b32 s48, 0
M_ms:
    ds_read_b64 v[26:27], v14 offset:8
    s_add_u32 s48, s48, 1
    s_waitcnt lgkmcnt(0)
    v_cmp_gt_u32 vcc, 4, v26
    s_cbranch_vccz M_ms_d
    s_cmp_ge_u32 s48, 2000000
    s_cbranch_scc1 M_ms_d
    s_sleep 1
    s_branch M_ms
M_ms_d:
    v_readfirstlane_b32 s39, v27
    s_cmp_lg_u32 s39, 0
    s_cbranch_scc1 M_zg
    v_and_b32 v26, 7, v1
    v_lshl_add_u32 v26, v26, 2, s51
    s_mov_b32 s48, 0
M_fz:
    global_load_dword v27, v26, s[28:29] sc1
    s_add_u32 s48, s48, 1
    s_waitcnt vmcnt(0)
    v_cmp_ne_u32 vcc, -1, v27
    s_cbranch_vccz M_fz_ok
    s_sleep 2
    s_cmp_lt_u32 s48, 200
    s_cbranch_scc1 M_fz
    s_mov_b32 s39, 1
    s_branch M_zg
M_fz_ok:
    s_mov_b32 s58, 0x400000
    s_mov_b32 s49, 0
    buffer_store_dwordx2 v[64:65], v246, s[56:59], s49 offen
    s_mov_b32 s49, 524288
    buffer_store_dwordx2 v[66:67], v246, s[56:59], s49 offen
    s_mov_b32 s49, 1048576
    buffer_store_dwordx2 v[68:69], v246, s[56:59], s49 offen
    s_mov_b32 s49, 1572864
    buffer_store_dwordx2 v[70:71], v246, s[56:59], s49 offen
    s_mov_b32 s49, 2097152
    buffer_store_dwordx2 v[72:73], v246, s[56:59], s49 offen
    s_mov_b32 s49, 2621440
    buffer_store_dwordx2 v[74:75], v246, s[56:59], s49 offen
    s_mov_b32 s49, 3145728
    buffer_store_dwordx2 v[76:77], v246, s[56:59], s49 offen
    s_mov_b32 s49, 3670016
    buffer_store_dwordx2 v[78:79], v246, s[56:59], s49 offen
    s_branch M_zd
M_zg:
    v_lshrrev_b32 v25, 3, v8
    v_lshl_add_u32 v18, v25, 15, v247
    v_lshrrev_b32 v25, 1, v9
    v_lshl_add_u32 v18, v25, 14, v18
    s_lshl_b32 s48, s35, 9
    s_lshl_b32 s49, s36, 7
    s_add_u32 s48, s48, s49
    s_add_u32 s48, s48, s69
    s_add_u32 s48, s48, 1048576
    v_add_u32 v18, s48, v18
    global_store_dwordx2 v18, v[64:65], s[30:31] sc1
    v_add_u32 v18, 0x10000, v18
    global_store_dwordx2 v18, v[66:67], s[30:31] sc1
    v_add_u32 v18, 0x10000, v18
    global_store_dwordx2 v18, v[68:69], s[30:31] sc1
    v_add_u32 v18, 0x10000, v18
    global_store_dwordx2 v18, v[70:71], s[30:31] sc1
    v_add_u32 v18, 0x10000, v18
    global_store_dwordx2 v18, v[72:73], s[30:31] sc1
    v_add_u32 v18, 0x10000, v18
    global_store_dwordx2 v18, v[74:75], s[30:31] sc1
    v_add_u32 v18, 0x10000, v18
    global_store_dwordx2 v18, v[76:77], s[30:31] sc1
    v_add_u32 v18, 0x10000, v18
    global_store_dwordx2 v18, v[78:79], s[30:31] sc1
    v_add_u32 v18, 0x10000, v18
    s_lshl_b32 s48, s35, 4
    s_lshl_b32 s49, s36, 2
    s_add_u32 s48, s48, s49
    s_add_u32 s48, s48, s69
    s_add_u32 s48, s48, 1753088
    v_mov_b32 v24, s48
    s_mov_b32 s48, 0
M_zgq:
    ds_read_b32 v26, v14 offset:84
    s_add_u32 s48, s48, 1
    s_waitcnt lgkmcnt(0)
    v_cmp_gt_u32 vcc, 4, v26
    s_cbranch_vccz M_zgq_d
    s_cmp_ge_u32 s48, 2000000
    s_cbranch_scc1 M_zgq_d
    s_sleep 1
    s_branch M_zgq
M_zgq_d:
    buffer_wbl2 sc1
    v_mov_b32 v26, v24
    v_mov_b32 v27, s38
    s_waitcnt vmcnt(0)
    s_mov_b64 exec, 1
    global_store_dword v26, v27, s[30:31] sc1
    s_mov_b64 exec, -1
    s_waitcnt vmcnt(0)
    s_branch M_zd
M_uretry:
    s_add_u32 s50, s50, 1
    s_cmp_ge_u32 s50, 160
    s_cbranch_scc1 M_slow
    s_sleep 1
    s_waitcnt lgkmcnt(0)
    global_load_dwordx4 v[140:143], v253, s[26:27] sc1
    global_load_dwordx4 v[136:139], v252, s[26:27] sc1
    global_load_dwordx4 v[132:135], v251, s[26:27] sc1
    global_load_dwordx4 v[128:131], v250, s[26:27] sc1
    global_load_dwordx4 v[160:163], v29, s[30:31] sc1
    s_branch M_up
M_slow:
    s_mov_b64 exec, 1
    ds_add_u32 v14, v15 offset:20
    s_mov_b64 exec, -1
    s_mov_b64 exec, 1
    ds_add_u32 v14, v15 offset:12
    s_mov_b64 exec, -1
    s_lshr_b32 s48, s71, 9
    s_load_dwordx2 s[50:51], s[10:11], s48
    s_mov_b64 s[56:57], s[6:7]
    s_mov_b32 s58, 0x400000
    s_mov_b32 s59, 0x20000
    s_mov_b64 s[60:61], s[8:9]
    s_mov_b32 s62, 0x400000
    s_mov_b32 s63, 0x20000
    s_lshr_b32 s48, s71, 11
    v_lshlrev_b32 v128, 11, v1
    v_add_u32 v128, s48, v128
    v_lshlrev_b32 v129, 1, v1
    v_sub_u32 v129, 4092, v129
    v_add_u32 v129, s66, v129
    v_mov_b32 v130, 0
    v_mov_b32 v131, s66
    ds_write_b16 v131, v130 offset:4094
    s_waitcnt lgkmcnt(0)
    s_lshl_b32 s64, s50, 16
    s_and_b32 s50, s50, 0xffff0000
    s_lshl_b32 s70, s51, 16
    s_and_b32 s51, s51, 0xffff0000
    s_mov_b32 s48, 0
M_slow_loop:
    buffer_load_ushort v136, v128, s[56:59], 0 offen
    v_subrev_u32 v132, 2048, v128
    buffer_load_ushort v137, v132, s[56:59], 0 offen
    v_subrev_u32 v132, 4096, v128
    buffer_load_ushort v138, v132, s[56:59], 0 offen
    v_subrev_u32 v132, 6144, v128
    buffer_load_ushort v139, v132, s[56:59], 0 offen
    buffer_load_ushort v140, v128, s[60:63], 0 offen
    s_waitcnt vmcnt(0)
    v_lshlrev_b32 v136, 16, v136
    v_lshlrev_b32 v137, 16, v137
    v_lshlrev_b32 v138, 16, v138
    v_lshlrev_b32 v139, 16, v139
    v_lshlrev_b32 v140, 16, v140
    v_mul_f32 v141, s51, v139
    v_fma_f32 v141, v138, s70, v141
    v_fma_f32 v141, v137, s50, v141
    v_fma_f32 v141, v136, s64, v141
    v_mul_f32 v141, v141, v140
    v_cvt_pk_bf16_f32 v141, v141, v141
    ds_write_b16 v129, v141
    ds_write_b16 v129, v141 offset:4578
    v_add_u32 v128, 0x20000, v128
    v_subrev_u32 v129, 128, v129
    s_add_u32 s48, s48, 1
    s_cmp_lt_u32 s48, 32
    s_cbranch_scc1 M_slow_loop
    s_waitcnt lgkmcnt(0)
    s_mov_b64 exec, 1
    ds_add_u32 v14, v15 offset:8
    s_mov_b64 exec, -1
    s_branch M_udone
B_fin:
B_end:
    s_endpgm
.section .rodata,"a"
.p2align 6
.amdhsa_kernel sequential_preLN__ssm_conv_h3__moe_arch_mod__prompt_kernel
  .amdhsa_next_free_vgpr 256
  .amdhsa_next_free_sgpr 102
  .amdhsa_accum_offset 256
  .amdhsa_group_segment_fixed_size 0
  .amdhsa_kernarg_size 112
  .amdhsa_user_sgpr_count 2
  .amdhsa_user_sgpr_kernarg_segment_ptr 1
  .amdhsa_system_sgpr_workgroup_id_x 1
  .amdhsa_float_denorm_mode_32 3
.end_amdhsa_kernel
```
